```python
import torch

def _softmax(x, axis=-1):
    return torch.softmax(x, dim=axis)
def _gelu(x):
    return torch.nn.functional.gelu(x, approximate="tanh")
def _silu(x):
    return torch.nn.functional.silu(x)
def _sigmoid(x):
    return torch.sigmoid(x)
def _layernorm(x, axis=-1, eps=1e-5):
    m = x.mean(dim=axis, keepdim=True)
    v = x.var(dim=axis, keepdim=True, unbiased=False)
    return (x - m) / torch.sqrt(v + eps)
def _scatter_add(tgt, idx, src, axis=0):
    return tgt.clone().index_add_(axis, idx, src)
def _segment_sum(src, seg, n):
    out = torch.zeros((n,) + src.shape[1:], dtype=src.dtype)
    return out.index_add_(0, seg, src)
def _pad(x, pw):
    flat = tuple(v for pair in reversed(pw) for v in pair)
    return torch.nn.functional.pad(x, flat)

kernel_name = 'sequential_preLN__gqa_block_cached__mixer_channel_mlp__decode'

def setup_inputs():

    _w = (lambda a: (lambda t: t.to(torch.bfloat16) if t.is_floating_point() else t)(torch.as_tensor(a)))
    def _A_setup():
        B, Sq, D = 1, 1, 512
        Hq, Hkv, Sk, Dh = 32, 32, 4096, 128
        assert Hq % Hkv == 0, (Hq, Hkv)
        return {
            "x": _w((lambda *s: torch.randn(*s, dtype=torch.bfloat16) * 0.05)(B, Sq, D)),
            "k_cache": _w((lambda *s: torch.randn(*s, dtype=torch.bfloat16) * 3.2)(B, Hkv, Sk, Dh)),
            "v_cache": _w((lambda *s: torch.randn(*s, dtype=torch.bfloat16) * 0.4)(B, Hkv, Sk, Dh)),
            "wq": _w((lambda *s: torch.randn(*s, dtype=torch.bfloat16) * 3.2)(D, Hq * Dh) * (D ** -0.5)),
            "wo": _w((lambda *s: torch.randn(*s, dtype=torch.bfloat16) * 0.4)(Hq * Dh, D) * ((Hq * Dh) ** -0.5)),
        }
    _A_in = _A_setup()

    def _B_setup():
        B, S, D, F = 1, 1, 512, 1376
        return {
            "x": _w((lambda *s: torch.randn(*s, dtype=torch.bfloat16) * 0.05)(B, S, D)),
            "w1": _w((lambda *s: torch.randn(*s, dtype=torch.bfloat16) * 3.2)(D, F) * (D ** -0.5)),
            "b1": _w((lambda *s: torch.randn(*s, dtype=torch.bfloat16) * 1.6)(F)),
            "w2": _w((lambda *s: torch.randn(*s, dtype=torch.bfloat16) * 0.1)(F, D) * (F ** -0.5)),
            "b2": _w((lambda *s: torch.randn(*s, dtype=torch.bfloat16) * 0.1)(D)),
        }
    _B_in = _B_setup()

    return {
        "A_x": _A_in["x"],
        "A_k_cache": _A_in["k_cache"],
        "A_v_cache": _A_in["v_cache"],
        "A_wq": _A_in["wq"],
        "A_wo": _A_in["wo"],
        "B_x": _B_in["x"],
        "B_w1": _B_in["w1"],
        "B_b1": _B_in["b1"],
        "B_w2": _B_in["w2"],
        "B_b2": _B_in["b2"],
    }

def reference(A_x, A_k_cache, A_v_cache, A_wq, A_wo, B_x, B_w1, B_b1, B_w2, B_b2):
    def _A_ref(x, k_cache, v_cache, wq, wo):
        B, Sq, D = x.shape
        Hq, Dh = 32, 128
        Hkv = k_cache.shape[1]
        rep = Hq // Hkv
        q = (lambda x, *d: x.permute(*d))((x @ wq).reshape(B, Sq, Hq, Dh), 0, 2, 1, 3)
        k = (lambda x, n, axis: torch.repeat_interleave(x, n, dim=axis))(k_cache, rep, axis=1)
        v = (lambda x, n, axis: torch.repeat_interleave(x, n, dim=axis))(v_cache, rep, axis=1)
        scores = torch.einsum("bhqd,bhkd->bhqk", q, k) * (Dh ** -0.5)
        p = _softmax(scores, axis=-1)
        o = torch.einsum("bhqk,bhkd->bhqd", p, v)
        return (lambda x, *d: x.permute(*d))(o, 0, 2, 1, 3).reshape(B, Sq, Hq * Dh) @ wo

    def _B_ref(x, w1, b1, w2, b2):
        y = _layernorm(x, axis=-1)
        h = _gelu(torch.einsum("bsd,df->bsf", y, w1) + b1)
        return torch.einsum("bsf,fd->bsd", h, w2) + b2

    x = A_x
    h = x + _A_ref(_layernorm(x, axis=-1), A_k_cache, A_v_cache, A_wq, A_wo)
    h2 = h + _B_ref(_layernorm(h, axis=-1), B_w1, B_b1, B_w2, B_b2)
    return h2
```

```asm
; @launch grid=(256,1,1) block=(576,1,1) lds=73728
.amdgcn_target "amdgcn-amd-amdhsa--gfx950"
.text
.globl sequential_preLN__gqa_block_cached__mixer_channel_mlp__decode_kernel
.p2align 8
.type sequential_preLN__gqa_block_cached__mixer_channel_mlp__decode_kernel,@function
sequential_preLN__gqa_block_cached__mixer_channel_mlp__decode_kernel:
    s_cmp_ge_u32 s2, 0x100
    s_cbranch_scc1 L_end
    s_load_dwordx16 s[56:71], s[0:1], 0
    s_load_dwordx8 s[72:79], s[0:1], 64
    s_load_dwordx2 s[32:33], s[0:1], 96
    v_lshrrev_b32 v3, 6, v0
    v_and_b32 v1, 63, v0
    v_mov_b32 v4, -1
    v_mov_b32 v5, -1
    v_lshlrev_b32 v2, 3, v0
    v_readfirstlane_b32 s82, v3
    ds_write_b64 v2, v[4:5]
    s_and_b32 s80, s2, 31
    s_lshr_b32 s81, s2, 5
    s_mov_b32 s34, 634880
    s_mov_b32 s35, 0x20000
    s_mov_b32 s39, 0x20000
    s_mov_b32 s90, 0x10000
    s_getreg_b32 s95, hwreg(HW_REG_XCC_ID)
    s_cmp_eq_u32 s82, 0
    s_cbranch_scc0 L_KV
    s_setprio 3
    s_mov_b32 s38, 4194304
    v_lshrrev_b32 v149, 4, v1
    v_and_b32 v150, 15, v1
    v_lshlrev_b32 v142, 4, v1
    s_lshl_b32 s86, s80, 3
    s_add_u32 s86, s86, s81
    v_mov_b32 v6, -1
    v_mov_b32 v7, -1
    v_mov_b32 v152, 2147483648
    s_mul_i32 s83, s86, 768
    s_add_u32 s83, s83, 262144
    s_mov_b32 exec_hi, 0xffff
    v_mov_b32 v152, s83
    s_lshl_b32 s83, s86, 10
    s_mov_b32 exec_hi, -1
    v_add_u32 v152, v152, v142
    v_add_u32 v154, s83, v142
    s_lshl_b32 s83, s80, 13
    v_add_u32 v155, s83, v142
    s_cmp_ge_u32 s2, 128
    s_cbranch_scc1 L_so
    s_lshl_b32 s83, s81, 20
    s_lshl_b32 s84, s80, 8
    s_add_u32 s83, s83, s84
    v_lshl_add_u32 v151, v149, 18, s83
    v_lshl_add_u32 v151, v150, 4, v151
    s_lshl_b32 s83, s81, 8
    v_lshl_add_u32 v143, v149, 6, s83
    v_lshl_add_u32 v143, v150, 1, v143
    s_waitcnt lgkmcnt(0)
    s_mov_b64 s[36:37], s[62:63]
    s_load_dword s94, s[32:33], 589824
    global_load_dwordx4 v[136:139], v142, s[56:57]
    global_load_ushort v140, v143, s[56:57]
    global_load_ushort v141, v143, s[56:57] offset:32
    buffer_store_dwordx4 v[4:7], v152, s[32:35], 0 offen sc1
    buffer_load_dwordx4 v[8:11], v151, s[36:39], 0 offen
    s_mov_b32 s83, 8192
    buffer_load_dwordx4 v[12:15], v151, s[36:39], s83 offen
    s_mov_b32 s83, 16384
    buffer_load_dwordx4 v[16:19], v151, s[36:39], s83 offen
    s_mov_b32 s83, 24576
    buffer_load_dwordx4 v[20:23], v151, s[36:39], s83 offen
    s_mov_b32 s83, 32768
    buffer_load_dwordx4 v[24:27], v151, s[36:39], s83 offen
    s_mov_b32 s83, 40960
    buffer_load_dwordx4 v[28:31], v151, s[36:39], s83 offen
    s_mov_b32 s83, 49152
    buffer_load_dwordx4 v[32:35], v151, s[36:39], s83 offen
    s_mov_b32 s83, 57344
    buffer_load_dwordx4 v[36:39], v151, s[36:39], s83 offen
    s_mov_b32 s83, 65536
    buffer_load_dwordx4 v[40:43], v151, s[36:39], s83 offen
    s_mov_b32 s83, 73728
    buffer_load_dwordx4 v[44:47], v151, s[36:39], s83 offen
    s_mov_b32 s83, 81920
    buffer_load_dwordx4 v[48:51], v151, s[36:39], s83 offen
    s_mov_b32 s83, 90112
    buffer_load_dwordx4 v[52:55], v151, s[36:39], s83 offen
    s_mov_b32 s83, 98304
    buffer_load_dwordx4 v[56:59], v151, s[36:39], s83 offen
    s_mov_b32 s83, 106496
    buffer_load_dwordx4 v[60:63], v151, s[36:39], s83 offen
    s_mov_b32 s83, 114688
    buffer_load_dwordx4 v[64:67], v151, s[36:39], s83 offen
    s_mov_b32 s83, 122880
    buffer_load_dwordx4 v[68:71], v151, s[36:39], s83 offen
    s_mov_b32 s83, 131072
    buffer_load_dwordx4 v[72:75], v151, s[36:39], s83 offen
    s_mov_b32 s83, 139264
    buffer_load_dwordx4 v[76:79], v151, s[36:39], s83 offen
    s_mov_b32 s83, 147456
    buffer_load_dwordx4 v[80:83], v151, s[36:39], s83 offen
    s_mov_b32 s83, 155648
    buffer_load_dwordx4 v[84:87], v151, s[36:39], s83 offen
    s_mov_b32 s83, 163840
    buffer_load_dwordx4 v[88:91], v151, s[36:39], s83 offen
    s_mov_b32 s83, 172032
    buffer_load_dwordx4 v[92:95], v151, s[36:39], s83 offen
    s_mov_b32 s83, 180224
    buffer_load_dwordx4 v[96:99], v151, s[36:39], s83 offen
    s_mov_b32 s83, 188416
    buffer_load_dwordx4 v[100:103], v151, s[36:39], s83 offen
    s_mov_b32 s83, 196608
    buffer_load_dwordx4 v[104:107], v151, s[36:39], s83 offen
    s_mov_b32 s83, 204800
    buffer_load_dwordx4 v[108:111], v151, s[36:39], s83 offen
    s_mov_b32 s83, 212992
    buffer_load_dwordx4 v[112:115], v151, s[36:39], s83 offen
    s_mov_b32 s83, 221184
    buffer_load_dwordx4 v[116:119], v151, s[36:39], s83 offen
    s_mov_b32 s83, 229376
    buffer_load_dwordx4 v[120:123], v151, s[36:39], s83 offen
    s_mov_b32 s83, 237568
    buffer_load_dwordx4 v[124:127], v151, s[36:39], s83 offen
    s_mov_b32 s83, 245760
    buffer_load_dwordx4 v[128:131], v151, s[36:39], s83 offen
    s_mov_b32 s83, 253952
    buffer_load_dwordx4 v[132:135], v151, s[36:39], s83 offen
    s_barrier
    v_and_b32 v142, 1, v1
    v_lshlrev_b32 v142, 4, v142
    v_mov_b32 v143, 0xffff
    v_lshlrev_b32 v142, v142, v143
    v_bfe_u32 v143, v1, 1, 2
    v_cmp_eq_u32 vcc, 0, v143
    s_nop 1
    v_cndmask_b32 v4, 0, v142, vcc
    v_cmp_eq_u32 vcc, 1, v143
    s_nop 1
    v_cndmask_b32 v5, 0, v142, vcc
    v_cmp_eq_u32 vcc, 2, v143
    s_nop 1
    v_cndmask_b32 v6, 0, v142, vcc
    v_cmp_eq_u32 vcc, 3, v143
    s_nop 1
    v_cndmask_b32 v7, 0, v142, vcc
    v_mov_b32 v144, 0x3f803f80
    s_waitcnt vmcnt(33)
    v_dot2_f32_bf16 v142, v136, v144, 0
    v_dot2_f32_bf16 v143, v136, v136, 0
    v_dot2_f32_bf16 v142, v137, v144, v142
    v_dot2_f32_bf16 v143, v137, v137, v143
    v_dot2_f32_bf16 v142, v138, v144, v142
    v_dot2_f32_bf16 v143, v138, v138, v143
    v_dot2_f32_bf16 v142, v139, v144, v142
    v_dot2_f32_bf16 v143, v139, v139, v143
    s_nop 1
    v_add_f32_dpp v142, v142, v142 row_ror:8 row_mask:0xf bank_mask:0xf
    v_add_f32_dpp v143, v143, v143 row_ror:8 row_mask:0xf bank_mask:0xf
    s_nop 0
    v_add_f32_dpp v142, v142, v142 row_ror:4 row_mask:0xf bank_mask:0xf
    v_add_f32_dpp v143, v143, v143 row_ror:4 row_mask:0xf bank_mask:0xf
    s_nop 0
    v_add_f32_dpp v142, v142, v142 row_ror:2 row_mask:0xf bank_mask:0xf
    v_add_f32_dpp v143, v143, v143 row_ror:2 row_mask:0xf bank_mask:0xf
    s_nop 0
    v_add_f32_dpp v142, v142, v142 row_ror:1 row_mask:0xf bank_mask:0xf
    v_add_f32_dpp v143, v143, v143 row_ror:1 row_mask:0xf bank_mask:0xf
    v_mov_b32 v144, v142
    v_mov_b32 v145, v143
    s_nop 0
    v_permlane16_swap_b32 v142, v144
    v_permlane16_swap_b32 v143, v145
    v_add_f32 v142, v142, v144
    v_add_f32 v143, v143, v145
    v_mov_b32 v144, v142
    v_mov_b32 v145, v143
    s_nop 0
    v_permlane32_swap_b32 v142, v144
    v_permlane32_swap_b32 v143, v145
    v_add_f32 v142, v142, v144
    v_add_f32 v143, v143, v145
    v_mul_f32 v142, 0x3b000000, v142
    v_mul_f32 v143, 0x3b000000, v143
    v_fma_f32 v143, -v142, v142, v143
    v_max_f32 v143, 0, v143
    v_cvt_pk_bf16_f32 v142, v142, v142
    v_and_b32 v142, 0xffff0000, v142
    v_cvt_pk_bf16_f32 v143, v143, v143
    v_and_b32 v143, 0xffff0000, v143
    v_add_f32 v143, 0x3727c5ac, v143
    v_cvt_pk_bf16_f32 v143, v143, v143
    v_and_b32 v143, 0xffff0000, v143
    v_sqrt_f32 v143, v143
    s_nop 0
    v_cvt_pk_bf16_f32 v143, v143, v143
    v_and_b32 v143, 0xffff0000, v143
    v_rcp_f32 v143, v143
    v_lshlrev_b32 v140, 16, v140
    v_sub_f32 v140, v140, v142
    v_cvt_pk_bf16_f32 v140, v140, v140
    v_and_b32 v140, 0xffff0000, v140
    v_mul_f32 v140, v140, v143
    v_cvt_pk_bf16_f32 v140, v140, v140
    v_lshlrev_b32 v141, 16, v141
    v_sub_f32 v141, v141, v142
    v_cvt_pk_bf16_f32 v141, v141, v141
    v_and_b32 v141, 0xffff0000, v141
    v_mul_f32 v141, v141, v143
    v_cvt_pk_bf16_f32 v141, v141, v141
    v_and_b32_dpp v156, v140, v4 row_newbcast:0 row_mask:0xf bank_mask:0xf
    v_and_b32_dpp v157, v140, v5 row_newbcast:0 row_mask:0xf bank_mask:0xf
    v_and_b32_dpp v158, v140, v6 row_newbcast:0 row_mask:0xf bank_mask:0xf
    v_and_b32_dpp v159, v140, v7 row_newbcast:0 row_mask:0xf bank_mask:0xf
    s_waitcnt vmcnt(31)
    s_nop 0
    v_mfma_f32_16x16x32_bf16 v[164:167], v[156:159], v[8:11], 0
    v_and_b32_dpp v160, v140, v4 row_newbcast:1 row_mask:0xf bank_mask:0xf
    v_and_b32_dpp v161, v140, v5 row_newbcast:1 row_mask:0xf bank_mask:0xf
    v_and_b32_dpp v162, v140, v6 row_newbcast:1 row_mask:0xf bank_mask:0xf
    v_and_b32_dpp v163, v140, v7 row_newbcast:1 row_mask:0xf bank_mask:0xf
    s_waitcnt vmcnt(30)
    s_nop 0
    v_mfma_f32_16x16x32_bf16 v[164:167], v[160:163], v[12:15], v[164:167]
    v_and_b32_dpp v156, v140, v4 row_newbcast:2 row_mask:0xf bank_mask:0xf
    v_and_b32_dpp v157, v140, v5 row_newbcast:2 row_mask:0xf bank_mask:0xf
    v_and_b32_dpp v158, v140, v6 row_newbcast:2 row_mask:0xf bank_mask:0xf
    v_and_b32_dpp v159, v140, v7 row_newbcast:2 row_mask:0xf bank_mask:0xf
    s_waitcnt vmcnt(29)
    s_nop 0
    v_mfma_f32_16x16x32_bf16 v[164:167], v[156:159], v[16:19], v[164:167]
    v_and_b32_dpp v160, v140, v4 row_newbcast:3 row_mask:0xf bank_mask:0xf
    v_and_b32_dpp v161, v140, v5 row_newbcast:3 row_mask:0xf bank_mask:0xf
    v_and_b32_dpp v162, v140, v6 row_newbcast:3 row_mask:0xf bank_mask:0xf
    v_and_b32_dpp v163, v140, v7 row_newbcast:3 row_mask:0xf bank_mask:0xf
    s_waitcnt vmcnt(28)
    s_nop 0
    v_mfma_f32_16x16x32_bf16 v[164:167], v[160:163], v[20:23], v[164:167]
    v_and_b32_dpp v156, v140, v4 row_newbcast:4 row_mask:0xf bank_mask:0xf
    v_and_b32_dpp v157, v140, v5 row_newbcast:4 row_mask:0xf bank_mask:0xf
    v_and_b32_dpp v158, v140, v6 row_newbcast:4 row_mask:0xf bank_mask:0xf
    v_and_b32_dpp v159, v140, v7 row_newbcast:4 row_mask:0xf bank_mask:0xf
    s_waitcnt vmcnt(27)
    s_nop 0
    v_mfma_f32_16x16x32_bf16 v[164:167], v[156:159], v[24:27], v[164:167]
    v_and_b32_dpp v160, v140, v4 row_newbcast:5 row_mask:0xf bank_mask:0xf
    v_and_b32_dpp v161, v140, v5 row_newbcast:5 row_mask:0xf bank_mask:0xf
    v_and_b32_dpp v162, v140, v6 row_newbcast:5 row_mask:0xf bank_mask:0xf
    v_and_b32_dpp v163, v140, v7 row_newbcast:5 row_mask:0xf bank_mask:0xf
    s_waitcnt vmcnt(26)
    s_nop 0
    v_mfma_f32_16x16x32_bf16 v[164:167], v[160:163], v[28:31], v[164:167]
    v_and_b32_dpp v156, v140, v4 row_newbcast:6 row_mask:0xf bank_mask:0xf
    v_and_b32_dpp v157, v140, v5 row_newbcast:6 row_mask:0xf bank_mask:0xf
    v_and_b32_dpp v158, v140, v6 row_newbcast:6 row_mask:0xf bank_mask:0xf
    v_and_b32_dpp v159, v140, v7 row_newbcast:6 row_mask:0xf bank_mask:0xf
    s_waitcnt vmcnt(25)
    s_nop 0
    v_mfma_f32_16x16x32_bf16 v[164:167], v[156:159], v[32:35], v[164:167]
    v_and_b32_dpp v160, v140, v4 row_newbcast:7 row_mask:0xf bank_mask:0xf
    v_and_b32_dpp v161, v140, v5 row_newbcast:7 row_mask:0xf bank_mask:0xf
    v_and_b32_dpp v162, v140, v6 row_newbcast:7 row_mask:0xf bank_mask:0xf
    v_and_b32_dpp v163, v140, v7 row_newbcast:7 row_mask:0xf bank_mask:0xf
    s_waitcnt vmcnt(24)
    s_nop 0
    v_mfma_f32_16x16x32_bf16 v[164:167], v[160:163], v[36:39], v[164:167]
    v_and_b32_dpp v156, v140, v4 row_newbcast:8 row_mask:0xf bank_mask:0xf
    v_and_b32_dpp v157, v140, v5 row_newbcast:8 row_mask:0xf bank_mask:0xf
    v_and_b32_dpp v158, v140, v6 row_newbcast:8 row_mask:0xf bank_mask:0xf
    v_and_b32_dpp v159, v140, v7 row_newbcast:8 row_mask:0xf bank_mask:0xf
    s_waitcnt vmcnt(23)
    s_nop 0
    v_mfma_f32_16x16x32_bf16 v[164:167], v[156:159], v[40:43], v[164:167]
    v_and_b32_dpp v160, v140, v4 row_newbcast:9 row_mask:0xf bank_mask:0xf
    v_and_b32_dpp v161, v140, v5 row_newbcast:9 row_mask:0xf bank_mask:0xf
    v_and_b32_dpp v162, v140, v6 row_newbcast:9 row_mask:0xf bank_mask:0xf
    v_and_b32_dpp v163, v140, v7 row_newbcast:9 row_mask:0xf bank_mask:0xf
    s_waitcnt vmcnt(22)
    s_nop 0
    v_mfma_f32_16x16x32_bf16 v[164:167], v[160:163], v[44:47], v[164:167]
    v_and_b32_dpp v156, v140, v4 row_newbcast:10 row_mask:0xf bank_mask:0xf
    v_and_b32_dpp v157, v140, v5 row_newbcast:10 row_mask:0xf bank_mask:0xf
    v_and_b32_dpp v158, v140, v6 row_newbcast:10 row_mask:0xf bank_mask:0xf
    v_and_b32_dpp v159, v140, v7 row_newbcast:10 row_mask:0xf bank_mask:0xf
    s_waitcnt vmcnt(21)
    s_nop 0
    v_mfma_f32_16x16x32_bf16 v[164:167], v[156:159], v[48:51], v[164:167]
    v_and_b32_dpp v160, v140, v4 row_newbcast:11 row_mask:0xf bank_mask:0xf
    v_and_b32_dpp v161, v140, v5 row_newbcast:11 row_mask:0xf bank_mask:0xf
    v_and_b32_dpp v162, v140, v6 row_newbcast:11 row_mask:0xf bank_mask:0xf
    v_and_b32_dpp v163, v140, v7 row_newbcast:11 row_mask:0xf bank_mask:0xf
    s_waitcnt vmcnt(20)
    s_nop 0
    v_mfma_f32_16x16x32_bf16 v[164:167], v[160:163], v[52:55], v[164:167]
    v_and_b32_dpp v156, v140, v4 row_newbcast:12 row_mask:0xf bank_mask:0xf
    v_and_b32_dpp v157, v140, v5 row_newbcast:12 row_mask:0xf bank_mask:0xf
    v_and_b32_dpp v158, v140, v6 row_newbcast:12 row_mask:0xf bank_mask:0xf
    v_and_b32_dpp v159, v140, v7 row_newbcast:12 row_mask:0xf bank_mask:0xf
    s_waitcnt vmcnt(19)
    s_nop 0
    v_mfma_f32_16x16x32_bf16 v[164:167], v[156:159], v[56:59], v[164:167]
    v_and_b32_dpp v160, v140, v4 row_newbcast:13 row_mask:0xf bank_mask:0xf
    v_and_b32_dpp v161, v140, v5 row_newbcast:13 row_mask:0xf bank_mask:0xf
    v_and_b32_dpp v162, v140, v6 row_newbcast:13 row_mask:0xf bank_mask:0xf
    v_and_b32_dpp v163, v140, v7 row_newbcast:13 row_mask:0xf bank_mask:0xf
    s_waitcnt vmcnt(18)
    s_nop 0
    v_mfma_f32_16x16x32_bf16 v[164:167], v[160:163], v[60:63], v[164:167]
    v_and_b32_dpp v156, v140, v4 row_newbcast:14 row_mask:0xf bank_mask:0xf
    v_and_b32_dpp v157, v140, v5 row_newbcast:14 row_mask:0xf bank_mask:0xf
    v_and_b32_dpp v158, v140, v6 row_newbcast:14 row_mask:0xf bank_mask:0xf
    v_and_b32_dpp v159, v140, v7 row_newbcast:14 row_mask:0xf bank_mask:0xf
    s_waitcnt vmcnt(17)
    s_nop 0
    v_mfma_f32_16x16x32_bf16 v[164:167], v[156:159], v[64:67], v[164:167]
    v_and_b32_dpp v160, v140, v4 row_newbcast:15 row_mask:0xf bank_mask:0xf
    v_and_b32_dpp v161, v140, v5 row_newbcast:15 row_mask:0xf bank_mask:0xf
    v_and_b32_dpp v162, v140, v6 row_newbcast:15 row_mask:0xf bank_mask:0xf
    v_and_b32_dpp v163, v140, v7 row_newbcast:15 row_mask:0xf bank_mask:0xf
    s_waitcnt vmcnt(16)
    s_nop 0
    v_mfma_f32_16x16x32_bf16 v[164:167], v[160:163], v[68:71], v[164:167]
    v_and_b32_dpp v156, v141, v4 row_newbcast:0 row_mask:0xf bank_mask:0xf
    v_and_b32_dpp v157, v141, v5 row_newbcast:0 row_mask:0xf bank_mask:0xf
    v_and_b32_dpp v158, v141, v6 row_newbcast:0 row_mask:0xf bank_mask:0xf
    v_and_b32_dpp v159, v141, v7 row_newbcast:0 row_mask:0xf bank_mask:0xf
    s_waitcnt vmcnt(15)
    s_nop 0
    v_mfma_f32_16x16x32_bf16 v[164:167], v[156:159], v[72:75], v[164:167]
    v_and_b32_dpp v160, v141, v4 row_newbcast:1 row_mask:0xf bank_mask:0xf
    v_and_b32_dpp v161, v141, v5 row_newbcast:1 row_mask:0xf bank_mask:0xf
    v_and_b32_dpp v162, v141, v6 row_newbcast:1 row_mask:0xf bank_mask:0xf
    v_and_b32_dpp v163, v141, v7 row_newbcast:1 row_mask:0xf bank_mask:0xf
    s_waitcnt vmcnt(14)
    s_nop 0
    v_mfma_f32_16x16x32_bf16 v[164:167], v[160:163], v[76:79], v[164:167]
    v_and_b32_dpp v156, v141, v4 row_newbcast:2 row_mask:0xf bank_mask:0xf
    v_and_b32_dpp v157, v141, v5 row_newbcast:2 row_mask:0xf bank_mask:0xf
    v_and_b32_dpp v158, v141, v6 row_newbcast:2 row_mask:0xf bank_mask:0xf
    v_and_b32_dpp v159, v141, v7 row_newbcast:2 row_mask:0xf bank_mask:0xf
    s_waitcnt vmcnt(13)
    s_nop 0
    v_mfma_f32_16x16x32_bf16 v[164:167], v[156:159], v[80:83], v[164:167]
    v_and_b32_dpp v160, v141, v4 row_newbcast:3 row_mask:0xf bank_mask:0xf
    v_and_b32_dpp v161, v141, v5 row_newbcast:3 row_mask:0xf bank_mask:0xf
    v_and_b32_dpp v162, v141, v6 row_newbcast:3 row_mask:0xf bank_mask:0xf
    v_and_b32_dpp v163, v141, v7 row_newbcast:3 row_mask:0xf bank_mask:0xf
    s_waitcnt vmcnt(12)
    s_nop 0
    v_mfma_f32_16x16x32_bf16 v[164:167], v[160:163], v[84:87], v[164:167]
    v_and_b32_dpp v156, v141, v4 row_newbcast:4 row_mask:0xf bank_mask:0xf
    v_and_b32_dpp v157, v141, v5 row_newbcast:4 row_mask:0xf bank_mask:0xf
    v_and_b32_dpp v158, v141, v6 row_newbcast:4 row_mask:0xf bank_mask:0xf
    v_and_b32_dpp v159, v141, v7 row_newbcast:4 row_mask:0xf bank_mask:0xf
    s_waitcnt vmcnt(11)
    s_nop 0
    v_mfma_f32_16x16x32_bf16 v[164:167], v[156:159], v[88:91], v[164:167]
    v_and_b32_dpp v160, v141, v4 row_newbcast:5 row_mask:0xf bank_mask:0xf
    v_and_b32_dpp v161, v141, v5 row_newbcast:5 row_mask:0xf bank_mask:0xf
    v_and_b32_dpp v162, v141, v6 row_newbcast:5 row_mask:0xf bank_mask:0xf
    v_and_b32_dpp v163, v141, v7 row_newbcast:5 row_mask:0xf bank_mask:0xf
    s_waitcnt vmcnt(10)
    s_nop 0
    v_mfma_f32_16x16x32_bf16 v[164:167], v[160:163], v[92:95], v[164:167]
    v_and_b32_dpp v156, v141, v4 row_newbcast:6 row_mask:0xf bank_mask:0xf
    v_and_b32_dpp v157, v141, v5 row_newbcast:6 row_mask:0xf bank_mask:0xf
    v_and_b32_dpp v158, v141, v6 row_newbcast:6 row_mask:0xf bank_mask:0xf
    v_and_b32_dpp v159, v141, v7 row_newbcast:6 row_mask:0xf bank_mask:0xf
    s_waitcnt vmcnt(9)
    s_nop 0
    v_mfma_f32_16x16x32_bf16 v[164:167], v[156:159], v[96:99], v[164:167]
    v_and_b32_dpp v160, v141, v4 row_newbcast:7 row_mask:0xf bank_mask:0xf
    v_and_b32_dpp v161, v141, v5 row_newbcast:7 row_mask:0xf bank_mask:0xf
    v_and_b32_dpp v162, v141, v6 row_newbcast:7 row_mask:0xf bank_mask:0xf
    v_and_b32_dpp v163, v141, v7 row_newbcast:7 row_mask:0xf bank_mask:0xf
    s_waitcnt vmcnt(8)
    s_nop 0
    v_mfma_f32_16x16x32_bf16 v[164:167], v[160:163], v[100:103], v[164:167]
    v_and_b32_dpp v156, v141, v4 row_newbcast:8 row_mask:0xf bank_mask:0xf
    v_and_b32_dpp v157, v141, v5 row_newbcast:8 row_mask:0xf bank_mask:0xf
    v_and_b32_dpp v158, v141, v6 row_newbcast:8 row_mask:0xf bank_mask:0xf
    v_and_b32_dpp v159, v141, v7 row_newbcast:8 row_mask:0xf bank_mask:0xf
    s_waitcnt vmcnt(7)
    s_nop 0
    v_mfma_f32_16x16x32_bf16 v[164:167], v[156:159], v[104:107], v[164:167]
    v_and_b32_dpp v160, v141, v4 row_newbcast:9 row_mask:0xf bank_mask:0xf
    v_and_b32_dpp v161, v141, v5 row_newbcast:9 row_mask:0xf bank_mask:0xf
    v_and_b32_dpp v162, v141, v6 row_newbcast:9 row_mask:0xf bank_mask:0xf
    v_and_b32_dpp v163, v141, v7 row_newbcast:9 row_mask:0xf bank_mask:0xf
    s_waitcnt vmcnt(6)
    s_nop 0
    v_mfma_f32_16x16x32_bf16 v[164:167], v[160:163], v[108:111], v[164:167]
    v_and_b32_dpp v156, v141, v4 row_newbcast:10 row_mask:0xf bank_mask:0xf
    v_and_b32_dpp v157, v141, v5 row_newbcast:10 row_mask:0xf bank_mask:0xf
    v_and_b32_dpp v158, v141, v6 row_newbcast:10 row_mask:0xf bank_mask:0xf
    v_and_b32_dpp v159, v141, v7 row_newbcast:10 row_mask:0xf bank_mask:0xf
    s_waitcnt vmcnt(5)
    s_nop 0
    v_mfma_f32_16x16x32_bf16 v[164:167], v[156:159], v[112:115], v[164:167]
    v_and_b32_dpp v160, v141, v4 row_newbcast:11 row_mask:0xf bank_mask:0xf
    v_and_b32_dpp v161, v141, v5 row_newbcast:11 row_mask:0xf bank_mask:0xf
    v_and_b32_dpp v162, v141, v6 row_newbcast:11 row_mask:0xf bank_mask:0xf
    v_and_b32_dpp v163, v141, v7 row_newbcast:11 row_mask:0xf bank_mask:0xf
    s_waitcnt vmcnt(4)
    s_nop 0
    v_mfma_f32_16x16x32_bf16 v[164:167], v[160:163], v[116:119], v[164:167]
    v_and_b32_dpp v156, v141, v4 row_newbcast:12 row_mask:0xf bank_mask:0xf
    v_and_b32_dpp v157, v141, v5 row_newbcast:12 row_mask:0xf bank_mask:0xf
    v_and_b32_dpp v158, v141, v6 row_newbcast:12 row_mask:0xf bank_mask:0xf
    v_and_b32_dpp v159, v141, v7 row_newbcast:12 row_mask:0xf bank_mask:0xf
    s_waitcnt vmcnt(3)
    s_nop 0
    v_mfma_f32_16x16x32_bf16 v[164:167], v[156:159], v[120:123], v[164:167]
    v_and_b32_dpp v160, v141, v4 row_newbcast:13 row_mask:0xf bank_mask:0xf
    v_and_b32_dpp v161, v141, v5 row_newbcast:13 row_mask:0xf bank_mask:0xf
    v_and_b32_dpp v162, v141, v6 row_newbcast:13 row_mask:0xf bank_mask:0xf
    v_and_b32_dpp v163, v141, v7 row_newbcast:13 row_mask:0xf bank_mask:0xf
    s_waitcnt vmcnt(2)
    s_nop 0
    v_mfma_f32_16x16x32_bf16 v[164:167], v[160:163], v[124:127], v[164:167]
    v_and_b32_dpp v156, v141, v4 row_newbcast:14 row_mask:0xf bank_mask:0xf
    v_and_b32_dpp v157, v141, v5 row_newbcast:14 row_mask:0xf bank_mask:0xf
    v_and_b32_dpp v158, v141, v6 row_newbcast:14 row_mask:0xf bank_mask:0xf
    v_and_b32_dpp v159, v141, v7 row_newbcast:14 row_mask:0xf bank_mask:0xf
    s_waitcnt vmcnt(1)
    s_nop 0
    v_mfma_f32_16x16x32_bf16 v[164:167], v[156:159], v[128:131], v[164:167]
    v_and_b32_dpp v160, v141, v4 row_newbcast:15 row_mask:0xf bank_mask:0xf
    v_and_b32_dpp v161, v141, v5 row_newbcast:15 row_mask:0xf bank_mask:0xf
    v_and_b32_dpp v162, v141, v6 row_newbcast:15 row_mask:0xf bank_mask:0xf
    v_and_b32_dpp v163, v141, v7 row_newbcast:15 row_mask:0xf bank_mask:0xf
    s_waitcnt vmcnt(0)
    s_nop 0
    v_mfma_f32_16x16x32_bf16 v[164:167], v[160:163], v[132:135], v[164:167]
    s_mov_b32 exec_lo, 0
    s_nop 6
    v_mov_b32 v164, v166
    v_mov_b32 v165, v167
    s_mov_b32 exec_lo, -1
    s_branch L_sq
L_so:
    s_and_b32 s83, s2, 7
    s_lshl_b32 s83, s83, 10
    s_and_b32 s84, s2, 0x38
    s_lshl_b32 s84, s84, 4
    s_add_u32 s83, s83, s84
    s_and_b32 s84, s2, 0x40
    s_lshl_b32 s84, s84, 7
    s_add_u32 s83, s83, s84
    s_add_u32 s83, s83, 458752
    v_and_b32 v144, 7, v1
    v_lshl_add_u32 v153, v144, 4, s83
    v_and_b32 v144, 56, v1
    v_lshl_add_u32 v153, v144, 11, v153
    s_lshl_b32 s83, s2, 10
    s_add_u32 s83, s83, 459776
    v_add_u32 v145, s83, v142
    s_waitcnt lgkmcnt(0)
    s_load_dword s94, s[32:33], 589824
    buffer_store_dwordx4 v[4:7], v152, s[32:35], 0 offen sc1
    buffer_store_dwordx4 v[4:7], v153, s[32:35], 0 offen sc1
    buffer_store_dwordx4 v[4:7], v145, s[32:35], 0 offen sc1
    s_barrier
    s_waitcnt vmcnt(0)
L_sq:
    s_waitcnt lgkmcnt(0)
    s_add_u32 s94, s94, 0x9e3779b1
    v_mov_b32 v167, s95
    v_mov_b32 v166, s94
    buffer_store_dwordx4 v[164:167], v154, s[32:35], 0 offen sc1
    v_lshlrev_b32 v136, 4, v150
    v_and_b32 v147, 1, v149
    v_lshl_add_u32 v136, v147, 3, v136
    v_and_b32 v147, 2, v149
    v_lshl_add_u32 v136, v147, 1, v136
    v_lshlrev_b32 v147, 2, v1
    v_mov_b32 v148, 0
    ds_write_b32 v147, v148 offset:4608
L_q:
    buffer_load_dwordx4 v[8:11], v155, s[32:35], 0 offen offset:0 sc1
    buffer_load_dwordx4 v[12:15], v155, s[32:35], 0 offen offset:1024 sc1
    buffer_load_dwordx4 v[16:19], v155, s[32:35], 0 offen offset:2048 sc1
    buffer_load_dwordx4 v[20:23], v155, s[32:35], 0 offen offset:3072 sc1
    s_waitcnt vmcnt(0)
    v_xor_b32 v10, s94, v10
    v_xor_b32 v14, s94, v14
    v_xor_b32 v18, s94, v18
    v_xor_b32 v22, s94, v22
    v_or3_b32 v142, v10, v14, v18
    v_or_b32 v142, v142, v22
    v_cmp_ne_u32 vcc, 0, v142
    v_pk_add_f32 v[8:9], v[8:9], v[12:13]
    v_pk_add_f32 v[16:17], v[16:17], v[20:21]
    v_pk_add_f32 v[8:9], v[8:9], v[16:17]
    v_cvt_pk_bf16_f32 v8, v8, v9
    s_cbranch_vccz L_q_ok
    s_sub_i32 s90, s90, 1
    s_cmp_lt_i32 s90, 0
    s_cbranch_scc0 L_q
L_q_ok:
    ds_write_b32 v136, v8 offset:64
    s_branch L_fin
L_KV:
    s_add_u32 s86, s82, 3
    s_and_b32 s86, s86, 3
    s_sub_u32 s89, s82, 1
    s_and_b32 s83, s2, 7
    s_cmp_ge_u32 s2, 120
    s_cselect_b32 s89, s83, s89
    s_mov_b32 s38, 33554432
    s_lshl_b32 s83, s80, 20
    s_lshl_b32 s84, s81, 17
    s_add_u32 s83, s83, s84
    s_lshl_b32 s84, s86, 15
    s_add_u32 s83, s83, s84
    v_lshl_add_u32 v2, v1, 4, s83
    s_lshr_b32 s88, s2, 3
    s_lshl_b32 s83, s82, 3
    s_add_u32 s88, s88, s83
    s_and_b32 s88, s88, 31
    s_lshl_b32 s88, s88, 10
    s_lshl_b32 s83, s89, 7
    v_and_b32 v145, 7, v1
    v_lshl_add_u32 v147, v145, 4, s83
    v_bfe_u32 v146, v1, 4, 1
    v_lshl_add_u32 v147, v146, 3, v147
    s_lshl_b32 s84, s86, 2
    v_mov_b32 v145, s84
    s_cmp_ge_u32 s2, 128
    s_waitcnt lgkmcnt(0)
    s_load_dword s94, s[32:33], 589824
    s_cbranch_scc1 L_nosm
    global_load_dwordx2 v[140:141], v147, s[56:57]
    global_load_dwordx2 v[142:143], v147, s[74:75]
L_nosm:
    s_cmp_ge_u32 s82, 5
    s_cselect_b32 s36, s60, s58
    s_cselect_b32 s37, s61, s59
    s_cselect_b32 s84, 16, 4864
    v_add_u32 v145, s84, v145
    s_cselect_b32 s83, 0, s2
    s_cmp_lt_u32 s83, 128
    s_cbranch_scc1 L_st
    s_and_b32 s83, s2, 7
    s_lshl_b32 s83, s83, 17
    s_and_b32 s84, s2, 0x38
    s_lshl_b32 s84, s84, 4
    s_add_u32 s83, s83, s84
    s_and_b32 s84, s2, 0x40
    s_lshl_b32 s84, s84, 15
    s_add_u32 s83, s83, s84
    v_and_b32 v146, 7, v1
    v_lshl_add_u32 v167, v146, 4, s83
    v_and_b32 v146, 56, v1
    v_lshl_add_u32 v167, v146, 7, v167
    s_mov_b64 s[40:41], s[64:65]
    s_mov_b32 s42, 4194304
    s_mov_b32 s43, 0x20000
    s_lshl_b32 s84, s86, 19
    s_lshl_b32 s85, s86, 16
    s_or_b32 s84, s84, s85
    s_and_b32 s84, s84, 0x110000
    s_lshl_b32 s85, s86, 13
    s_add_u32 m0, s85, 8192
    s_barrier
    s_xor_b32 s83, s88, 0
    buffer_load_dwordx4 v[8:11], v2, s[36:39], s83 offen nt
    buffer_load_dwordx4 v167, s[40:43], s84 offen lds
    s_xor_b32 s83, s88, 1024
    buffer_load_dwordx4 v[12:15], v2, s[36:39], s83 offen nt
    s_xor_b32 s83, s88, 2048
    buffer_load_dwordx4 v[16:19], v2, s[36:39], s83 offen nt
    s_xor_b32 s83, s88, 3072
    buffer_load_dwordx4 v[20:23], v2, s[36:39], s83 offen nt
    s_xor_b32 s83, s88, 4096
    buffer_load_dwordx4 v[24:27], v2, s[36:39], s83 offen nt
    s_add_u32 m0, m0, 1024
    s_add_u32 s84, s84, 8192
    buffer_load_dwordx4 v167, s[40:43], s84 offen lds
    s_xor_b32 s83, s88, 5120
    buffer_load_dwordx4 v[28:31], v2, s[36:39], s83 offen nt
    s_xor_b32 s83, s88, 6144
    buffer_load_dwordx4 v[32:35], v2, s[36:39], s83 offen nt
    s_xor_b32 s83, s88, 7168
    buffer_load_dwordx4 v[36:39], v2, s[36:39], s83 offen nt
    s_xor_b32 s83, s88, 8192
    buffer_load_dwordx4 v[40:43], v2, s[36:39], s83 offen nt
    s_add_u32 m0, m0, 1024
    s_add_u32 s84, s84, 8192
    buffer_load_dwordx4 v167, s[40:43], s84 offen lds
    s_xor_b32 s83, s88, 9216
    buffer_load_dwordx4 v[44:47], v2, s[36:39], s83 offen nt
    s_xor_b32 s83, s88, 10240
    buffer_load_dwordx4 v[48:51], v2, s[36:39], s83 offen nt
    s_xor_b32 s83, s88, 11264
    buffer_load_dwordx4 v[52:55], v2, s[36:39], s83 offen nt
    s_xor_b32 s83, s88, 12288
    buffer_load_dwordx4 v[56:59], v2, s[36:39], s83 offen nt
    s_add_u32 m0, m0, 1024
    s_add_u32 s84, s84, 8192
    buffer_load_dwordx4 v167, s[40:43], s84 offen lds
    s_xor_b32 s83, s88, 13312
    buffer_load_dwordx4 v[60:63], v2, s[36:39], s83 offen nt
    s_xor_b32 s83, s88, 14336
    buffer_load_dwordx4 v[64:67], v2, s[36:39], s83 offen nt
    s_xor_b32 s83, s88, 15360
    buffer_load_dwordx4 v[68:71], v2, s[36:39], s83 offen nt
    s_xor_b32 s83, s88, 16384
    buffer_load_dwordx4 v[72:75], v2, s[36:39], s83 offen nt
    s_add_u32 m0, m0, 1024
    s_add_u32 s84, s84, 8192
    buffer_load_dwordx4 v167, s[40:43], s84 offen lds
    s_xor_b32 s83, s88, 17408
    buffer_load_dwordx4 v[76:79], v2, s[36:39], s83 offen nt
    s_xor_b32 s83, s88, 18432
    buffer_load_dwordx4 v[80:83], v2, s[36:39], s83 offen nt
    s_xor_b32 s83, s88, 19456
    buffer_load_dwordx4 v[84:87], v2, s[36:39], s83 offen nt
    s_xor_b32 s83, s88, 20480
    buffer_load_dwordx4 v[88:91], v2, s[36:39], s83 offen nt
    s_add_u32 m0, m0, 1024
    s_add_u32 s84, s84, 8192
    buffer_load_dwordx4 v167, s[40:43], s84 offen lds
    s_xor_b32 s83, s88, 21504
    buffer_load_dwordx4 v[92:95], v2, s[36:39], s83 offen nt
    s_xor_b32 s83, s88, 22528
    buffer_load_dwordx4 v[96:99], v2, s[36:39], s83 offen nt
    s_xor_b32 s83, s88, 23552
    buffer_load_dwordx4 v[100:103], v2, s[36:39], s83 offen nt
    s_xor_b32 s83, s88, 24576
    buffer_load_dwordx4 v[104:107], v2, s[36:39], s83 offen nt
    s_add_u32 m0, m0, 1024
    s_add_u32 s84, s84, 8192
    buffer_load_dwordx4 v167, s[40:43], s84 offen lds
    s_xor_b32 s83, s88, 25600
    buffer_load_dwordx4 v[108:111], v2, s[36:39], s83 offen nt
    s_xor_b32 s83, s88, 26624
    buffer_load_dwordx4 v[112:115], v2, s[36:39], s83 offen nt
    s_xor_b32 s83, s88, 27648
    buffer_load_dwordx4 v[116:119], v2, s[36:39], s83 offen nt
    s_xor_b32 s83, s88, 28672
    buffer_load_dwordx4 v[120:123], v2, s[36:39], s83 offen nt
    s_add_u32 m0, m0, 1024
    s_add_u32 s84, s84, 8192
    buffer_load_dwordx4 v167, s[40:43], s84 offen lds
    s_xor_b32 s83, s88, 29696
    buffer_load_dwordx4 v[124:127], v2, s[36:39], s83 offen nt
    s_xor_b32 s83, s88, 30720
    buffer_load_dwordx4 v[128:131], v2, s[36:39], s83 offen nt
    s_xor_b32 s83, s88, 31744
    buffer_load_dwordx4 v[132:135], v2, s[36:39], s83 offen nt
    s_branch L_st2
L_st:
    s_barrier
    s_xor_b32 s83, s88, 0
    buffer_load_dwordx4 v[8:11], v2, s[36:39], s83 offen nt
    s_xor_b32 s83, s88, 1024
    buffer_load_dwordx4 v[12:15], v2, s[36:39], s83 offen nt
    s_xor_b32 s83, s88, 2048
    buffer_load_dwordx4 v[16:19], v2, s[36:39], s83 offen nt
    s_xor_b32 s83, s88, 3072
    buffer_load_dwordx4 v[20:23], v2, s[36:39], s83 offen nt
    s_xor_b32 s83, s88, 4096
    buffer_load_dwordx4 v[24:27], v2, s[36:39], s83 offen nt
    s_xor_b32 s83, s88, 5120
    buffer_load_dwordx4 v[28:31], v2, s[36:39], s83 offen nt
    s_xor_b32 s83, s88, 6144
    buffer_load_dwordx4 v[32:35], v2, s[36:39], s83 offen nt
    s_xor_b32 s83, s88, 7168
    buffer_load_dwordx4 v[36:39], v2, s[36:39], s83 offen nt
    s_xor_b32 s83, s88, 8192
    buffer_load_dwordx4 v[40:43], v2, s[36:39], s83 offen nt
    s_xor_b32 s83, s88, 9216
    buffer_load_dwordx4 v[44:47], v2, s[36:39], s83 offen nt
    s_xor_b32 s83, s88, 10240
    buffer_load_dwordx4 v[48:51], v2, s[36:39], s83 offen nt
    s_xor_b32 s83, s88, 11264
    buffer_load_dwordx4 v[52:55], v2, s[36:39], s83 offen nt
    s_xor_b32 s83, s88, 12288
    buffer_load_dwordx4 v[56:59], v2, s[36:39], s83 offen nt
    s_xor_b32 s83, s88, 13312
    buffer_load_dwordx4 v[60:63], v2, s[36:39], s83 offen nt
    s_xor_b32 s83, s88, 14336
    buffer_load_dwordx4 v[64:67], v2, s[36:39], s83 offen nt
    s_xor_b32 s83, s88, 15360
    buffer_load_dwordx4 v[68:71], v2, s[36:39], s83 offen nt
    s_xor_b32 s83, s88, 16384
    buffer_load_dwordx4 v[72:75], v2, s[36:39], s83 offen nt
    s_xor_b32 s83, s88, 17408
    buffer_load_dwordx4 v[76:79], v2, s[36:39], s83 offen nt
    s_xor_b32 s83, s88, 18432
    buffer_load_dwordx4 v[80:83], v2, s[36:39], s83 offen nt
    s_xor_b32 s83, s88, 19456
    buffer_load_dwordx4 v[84:87], v2, s[36:39], s83 offen nt
    ds_write_b32 v145, v1 offset:32
    s_xor_b32 s83, s88, 20480
    buffer_load_dwordx4 v[88:91], v2, s[36:39], s83 offen nt
    s_xor_b32 s83, s88, 21504
    buffer_load_dwordx4 v[92:95], v2, s[36:39], s83 offen nt
    s_xor_b32 s83, s88, 22528
    buffer_load_dwordx4 v[96:99], v2, s[36:39], s83 offen nt
    s_xor_b32 s83, s88, 23552
    buffer_load_dwordx4 v[100:103], v2, s[36:39], s83 offen nt
    s_xor_b32 s83, s88, 24576
    buffer_load_dwordx4 v[104:107], v2, s[36:39], s83 offen nt
    s_xor_b32 s83, s88, 25600
    buffer_load_dwordx4 v[108:111], v2, s[36:39], s83 offen nt
    s_xor_b32 s83, s88, 26624
    buffer_load_dwordx4 v[112:115], v2, s[36:39], s83 offen nt
    s_xor_b32 s83, s88, 27648
    buffer_load_dwordx4 v[116:119], v2, s[36:39], s83 offen nt
    s_xor_b32 s83, s88, 28672
    buffer_load_dwordx4 v[120:123], v2, s[36:39], s83 offen nt
    s_xor_b32 s83, s88, 29696
    buffer_load_dwordx4 v[124:127], v2, s[36:39], s83 offen nt
    s_xor_b32 s83, s88, 30720
    buffer_load_dwordx4 v[128:131], v2, s[36:39], s83 offen nt
    s_xor_b32 s83, s88, 31744
    buffer_load_dwordx4 v[132:135], v2, s[36:39], s83 offen nt
    ds_write_b32 v145, v1
L_st2:
    s_lshl_b32 s83, s86, 9
    v_lshl_add_u32 v2, v1, 3, s83
    s_cmp_ge_u32 s82, 5
    s_cbranch_scc1 L_V
    s_and_b32 s88, s2, 7
    s_and_b32 s83, s86, 2
    s_lshl2_add_u32 s88, s83, s88
    s_and_b32 s83, s2, 0x40
    s_lshr_b32 s83, s83, 2
    s_add_u32 s88, s88, s83
    s_add_u32 s83, s86, 4
    s_lshl_b32 s83, s83, 10
    v_and_b32 v145, 31, v1
    v_lshl_add_u32 v3, v145, 13, s83
    s_cmp_lt_u32 s2, 128
    s_cbranch_scc1 L_k1
    s_lshl_b32 s83, s88, 13
    v_and_b32 v145, 7, v1
    v_lshl_add_u32 v3, v145, 10, s83
L_k1:
    v_and_b32 v146, 15, v1
    v_lshlrev_b32 v147, 4, v146
    v_and_b32 v145, 1, v1
    v_lshlrev_b32 v145, 4, v145
    v_mov_b32 v146, 0xffff
    v_lshlrev_b32 v145, v145, v146
    v_bfe_u32 v146, v1, 1, 2
    v_cmp_eq_u32 vcc, 0, v146
    s_nop 1
    v_cndmask_b32 v4, 0, v145, vcc
    v_cmp_eq_u32 vcc, 1, v146
    s_nop 1
    v_cndmask_b32 v5, 0, v145, vcc
    v_cmp_eq_u32 vcc, 2, v146
    s_nop 1
    v_cndmask_b32 v6, 0, v145, vcc
    v_cmp_eq_u32 vcc, 3, v146
    s_nop 1
    v_cndmask_b32 v7, 0, v145, vcc
    s_mov_b32 s48, 0xcccccccc
    s_mov_b32 s49, 0xcccccccc
    s_mov_b32 s50, 0xaaaaaaaa
    s_mov_b32 s51, 0xaaaaaaaa
L_lq:
    ds_read_b128 v[136:139], v147 offset:64
    s_waitcnt lgkmcnt(0)
    v_max3_u32 v146, v136, v137, v138
    v_max_u32 v146, v146, v139
    v_cmp_eq_u32 vcc, -1, v146
    s_cbranch_vccz L_lq_ok
    s_sub_i32 s90, s90, 1
    s_cmp_lt_i32 s90, 0
    s_cbranch_scc0 L_lq
L_lq_ok:
    buffer_load_dwordx2 v[150:151], v3, s[32:35], 0 offen offset:8 sc1
    s_add_u32 s94, s94, 0x9e3779b1
    s_waitcnt vmcnt(32)
    v_dot2_f32_bf16 v8, v8, v136, 0
    v_dot2_f32_bf16 v8, v9, v137, v8
    v_dot2_f32_bf16 v8, v10, v138, v8
    v_dot2_f32_bf16 v8, v11, v139, v8
    s_waitcnt vmcnt(31)
    v_dot2_f32_bf16 v12, v12, v136, 0
    v_dot2_f32_bf16 v12, v13, v137, v12
    v_dot2_f32_bf16 v12, v14, v138, v12
    v_dot2_f32_bf16 v12, v15, v139, v12
    s_waitcnt vmcnt(30)
    v_dot2_f32_bf16 v16, v16, v136, 0
    v_dot2_f32_bf16 v16, v17, v137, v16
    v_dot2_f32_bf16 v16, v18, v138, v16
    v_dot2_f32_bf16 v16, v19, v139, v16
    s_waitcnt vmcnt(29)
    v_dot2_f32_bf16 v20, v20, v136, 0
    v_dot2_f32_bf16 v20, v21, v137, v20
    v_dot2_f32_bf16 v20, v22, v138, v20
    v_dot2_f32_bf16 v20, v23, v139, v20
    s_waitcnt vmcnt(28)
    v_dot2_f32_bf16 v24, v24, v136, 0
    v_dot2_f32_bf16 v24, v25, v137, v24
    v_dot2_f32_bf16 v24, v26, v138, v24
    v_dot2_f32_bf16 v24, v27, v139, v24
    s_waitcnt vmcnt(27)
    v_dot2_f32_bf16 v28, v28, v136, 0
    v_dot2_f32_bf16 v28, v29, v137, v28
    v_dot2_f32_bf16 v28, v30, v138, v28
    v_dot2_f32_bf16 v28, v31, v139, v28
    s_waitcnt vmcnt(26)
    v_dot2_f32_bf16 v32, v32, v136, 0
    v_dot2_f32_bf16 v32, v33, v137, v32
    v_dot2_f32_bf16 v32, v34, v138, v32
    v_dot2_f32_bf16 v32, v35, v139, v32
    s_waitcnt vmcnt(25)
    v_dot2_f32_bf16 v36, v36, v136, 0
    v_dot2_f32_bf16 v36, v37, v137, v36
    v_dot2_f32_bf16 v36, v38, v138, v36
    v_dot2_f32_bf16 v36, v39, v139, v36
    s_waitcnt vmcnt(24)
    v_dot2_f32_bf16 v40, v40, v136, 0
    v_dot2_f32_bf16 v40, v41, v137, v40
    v_dot2_f32_bf16 v40, v42, v138, v40
    v_dot2_f32_bf16 v40, v43, v139, v40
    s_waitcnt vmcnt(23)
    v_dot2_f32_bf16 v44, v44, v136, 0
    v_dot2_f32_bf16 v44, v45, v137, v44
    v_dot2_f32_bf16 v44, v46, v138, v44
    v_dot2_f32_bf16 v44, v47, v139, v44
    s_waitcnt vmcnt(22)
    v_dot2_f32_bf16 v48, v48, v136, 0
    v_dot2_f32_bf16 v48, v49, v137, v48
    v_dot2_f32_bf16 v48, v50, v138, v48
    v_dot2_f32_bf16 v48, v51, v139, v48
    s_waitcnt vmcnt(21)
    v_dot2_f32_bf16 v52, v52, v136, 0
    v_dot2_f32_bf16 v52, v53, v137, v52
    v_dot2_f32_bf16 v52, v54, v138, v52
    v_dot2_f32_bf16 v52, v55, v139, v52
    s_waitcnt vmcnt(20)
    v_dot2_f32_bf16 v56, v56, v136, 0
    v_dot2_f32_bf16 v56, v57, v137, v56
    v_dot2_f32_bf16 v56, v58, v138, v56
    v_dot2_f32_bf16 v56, v59, v139, v56
    s_waitcnt vmcnt(19)
    v_dot2_f32_bf16 v60, v60, v136, 0
    v_dot2_f32_bf16 v60, v61, v137, v60
    v_dot2_f32_bf16 v60, v62, v138, v60
    v_dot2_f32_bf16 v60, v63, v139, v60
    s_waitcnt vmcnt(18)
    v_dot2_f32_bf16 v64, v64, v136, 0
    v_dot2_f32_bf16 v64, v65, v137, v64
    v_dot2_f32_bf16 v64, v66, v138, v64
    v_dot2_f32_bf16 v64, v67, v139, v64
    s_waitcnt vmcnt(17)
    v_dot2_f32_bf16 v68, v68, v136, 0
    v_dot2_f32_bf16 v68, v69, v137, v68
    v_dot2_f32_bf16 v68, v70, v138, v68
    v_dot2_f32_bf16 v68, v71, v139, v68
    s_waitcnt vmcnt(16)
    v_dot2_f32_bf16 v72, v72, v136, 0
    v_dot2_f32_bf16 v72, v73, v137, v72
    v_dot2_f32_bf16 v72, v74, v138, v72
    v_dot2_f32_bf16 v72, v75, v139, v72
    s_waitcnt vmcnt(15)
    v_dot2_f32_bf16 v76, v76, v136, 0
    v_dot2_f32_bf16 v76, v77, v137, v76
    v_dot2_f32_bf16 v76, v78, v138, v76
    v_dot2_f32_bf16 v76, v79, v139, v76
    s_waitcnt vmcnt(14)
    v_dot2_f32_bf16 v80, v80, v136, 0
    v_dot2_f32_bf16 v80, v81, v137, v80
    v_dot2_f32_bf16 v80, v82, v138, v80
    v_dot2_f32_bf16 v80, v83, v139, v80
    s_waitcnt vmcnt(13)
    v_dot2_f32_bf16 v84, v84, v136, 0
    v_dot2_f32_bf16 v84, v85, v137, v84
    v_dot2_f32_bf16 v84, v86, v138, v84
    v_dot2_f32_bf16 v84, v87, v139, v84
    s_waitcnt vmcnt(12)
    v_dot2_f32_bf16 v88, v88, v136, 0
    v_dot2_f32_bf16 v88, v89, v137, v88
    v_dot2_f32_bf16 v88, v90, v138, v88
    v_dot2_f32_bf16 v88, v91, v139, v88
    s_waitcnt vmcnt(11)
    v_dot2_f32_bf16 v92, v92, v136, 0
    v_dot2_f32_bf16 v92, v93, v137, v92
    v_dot2_f32_bf16 v92, v94, v138, v92
    v_dot2_f32_bf16 v92, v95, v139, v92
    s_waitcnt vmcnt(10)
    v_dot2_f32_bf16 v96, v96, v136, 0
    v_dot2_f32_bf16 v96, v97, v137, v96
    v_dot2_f32_bf16 v96, v98, v138, v96
    v_dot2_f32_bf16 v96, v99, v139, v96
    s_waitcnt vmcnt(9)
    v_dot2_f32_bf16 v100, v100, v136, 0
    v_dot2_f32_bf16 v100, v101, v137, v100
    v_dot2_f32_bf16 v100, v102, v138, v100
    v_dot2_f32_bf16 v100, v103, v139, v100
    s_waitcnt vmcnt(8)
    v_dot2_f32_bf16 v104, v104, v136, 0
    v_dot2_f32_bf16 v104, v105, v137, v104
    v_dot2_f32_bf16 v104, v106, v138, v104
    v_dot2_f32_bf16 v104, v107, v139, v104
    s_waitcnt vmcnt(7)
    v_dot2_f32_bf16 v108, v108, v136, 0
    v_dot2_f32_bf16 v108, v109, v137, v108
    v_dot2_f32_bf16 v108, v110, v138, v108
    v_dot2_f32_bf16 v108, v111, v139, v108
    s_waitcnt vmcnt(6)
    v_dot2_f32_bf16 v112, v112, v136, 0
    v_dot2_f32_bf16 v112, v113, v137, v112
    v_dot2_f32_bf16 v112, v114, v138, v112
    v_dot2_f32_bf16 v112, v115, v139, v112
    s_waitcnt vmcnt(5)
    v_dot2_f32_bf16 v116, v116, v136, 0
    v_dot2_f32_bf16 v116, v117, v137, v116
    v_dot2_f32_bf16 v116, v118, v138, v116
    v_dot2_f32_bf16 v116, v119, v139, v116
    s_waitcnt vmcnt(4)
    v_dot2_f32_bf16 v120, v120, v136, 0
    v_dot2_f32_bf16 v120, v121, v137, v120
    v_dot2_f32_bf16 v120, v122, v138, v120
    v_dot2_f32_bf16 v120, v123, v139, v120
    s_waitcnt vmcnt(3)
    v_dot2_f32_bf16 v124, v124, v136, 0
    v_dot2_f32_bf16 v124, v125, v137, v124
    v_dot2_f32_bf16 v124, v126, v138, v124
    v_dot2_f32_bf16 v124, v127, v139, v124
    s_waitcnt vmcnt(2)
    v_dot2_f32_bf16 v128, v128, v136, 0
    v_dot2_f32_bf16 v128, v129, v137, v128
    v_dot2_f32_bf16 v128, v130, v138, v128
    v_dot2_f32_bf16 v128, v131, v139, v128
    s_waitcnt vmcnt(1)
    v_dot2_f32_bf16 v132, v132, v136, 0
    v_dot2_f32_bf16 v132, v133, v137, v132
    v_dot2_f32_bf16 v132, v134, v138, v132
    v_dot2_f32_bf16 v132, v135, v139, v132
    v_add_f32_dpp v9, v8, v8 row_ror:8 row_mask:0xf bank_mask:0x3
    v_add_f32_dpp v73, v72, v72 row_ror:8 row_mask:0xf bank_mask:0x3
    v_add_f32_dpp v13, v12, v12 row_ror:8 row_mask:0xf bank_mask:0x3
    v_add_f32_dpp v77, v76, v76 row_ror:8 row_mask:0xf bank_mask:0x3
    v_add_f32_dpp v17, v16, v16 row_ror:8 row_mask:0xf bank_mask:0x3
    v_add_f32_dpp v81, v80, v80 row_ror:8 row_mask:0xf bank_mask:0x3
    v_add_f32_dpp v21, v20, v20 row_ror:8 row_mask:0xf bank_mask:0x3
    v_add_f32_dpp v85, v84, v84 row_ror:8 row_mask:0xf bank_mask:0x3
    v_add_f32_dpp v25, v24, v24 row_ror:8 row_mask:0xf bank_mask:0x3
    v_add_f32_dpp v89, v88, v88 row_ror:8 row_mask:0xf bank_mask:0x3
    v_add_f32_dpp v29, v28, v28 row_ror:8 row_mask:0xf bank_mask:0x3
    v_add_f32_dpp v93, v92, v92 row_ror:8 row_mask:0xf bank_mask:0x3
    v_add_f32_dpp v33, v32, v32 row_ror:8 row_mask:0xf bank_mask:0x3
    v_add_f32_dpp v97, v96, v96 row_ror:8 row_mask:0xf bank_mask:0x3
    v_add_f32_dpp v37, v36, v36 row_ror:8 row_mask:0xf bank_mask:0x3
    v_add_f32_dpp v101, v100, v100 row_ror:8 row_mask:0xf bank_mask:0x3
    v_add_f32_dpp v9, v40, v40 row_ror:8 row_mask:0xf bank_mask:0xc
    v_add_f32_dpp v73, v104, v104 row_ror:8 row_mask:0xf bank_mask:0xc
    v_add_f32_dpp v13, v44, v44 row_ror:8 row_mask:0xf bank_mask:0xc
    v_add_f32_dpp v77, v108, v108 row_ror:8 row_mask:0xf bank_mask:0xc
    v_add_f32_dpp v17, v48, v48 row_ror:8 row_mask:0xf bank_mask:0xc
    v_add_f32_dpp v81, v112, v112 row_ror:8 row_mask:0xf bank_mask:0xc
    v_add_f32_dpp v21, v52, v52 row_ror:8 row_mask:0xf bank_mask:0xc
    v_add_f32_dpp v85, v116, v116 row_ror:8 row_mask:0xf bank_mask:0xc
    v_add_f32_dpp v25, v56, v56 row_ror:8 row_mask:0xf bank_mask:0xc
    v_add_f32_dpp v89, v120, v120 row_ror:8 row_mask:0xf bank_mask:0xc
    v_add_f32_dpp v29, v60, v60 row_ror:8 row_mask:0xf bank_mask:0xc
    v_add_f32_dpp v93, v124, v124 row_ror:8 row_mask:0xf bank_mask:0xc
    v_add_f32_dpp v33, v64, v64 row_ror:8 row_mask:0xf bank_mask:0xc
    v_add_f32_dpp v97, v128, v128 row_ror:8 row_mask:0xf bank_mask:0xc
    v_add_f32_dpp v37, v68, v68 row_ror:8 row_mask:0xf bank_mask:0xc
    v_add_f32_dpp v101, v132, v132 row_ror:8 row_mask:0xf bank_mask:0xc
    v_add_f32_dpp v41, v9, v9 row_half_mirror row_mask:0xf bank_mask:0x5
    v_add_f32_dpp v105, v73, v73 row_half_mirror row_mask:0xf bank_mask:0x5
    v_add_f32_dpp v45, v13, v13 row_half_mirror row_mask:0xf bank_mask:0x5
    v_add_f32_dpp v109, v77, v77 row_half_mirror row_mask:0xf bank_mask:0x5
    v_add_f32_dpp v49, v17, v17 row_half_mirror row_mask:0xf bank_mask:0x5
    v_add_f32_dpp v113, v81, v81 row_half_mirror row_mask:0xf bank_mask:0x5
    v_add_f32_dpp v53, v21, v21 row_half_mirror row_mask:0xf bank_mask:0x5
    v_add_f32_dpp v117, v85, v85 row_half_mirror row_mask:0xf bank_mask:0x5
    v_add_f32_dpp v41, v25, v25 row_half_mirror row_mask:0xf bank_mask:0xa
    v_add_f32_dpp v105, v89, v89 row_half_mirror row_mask:0xf bank_mask:0xa
    v_add_f32_dpp v45, v29, v29 row_half_mirror row_mask:0xf bank_mask:0xa
    v_add_f32_dpp v109, v93, v93 row_half_mirror row_mask:0xf bank_mask:0xa
    v_add_f32_dpp v49, v33, v33 row_half_mirror row_mask:0xf bank_mask:0xa
    v_add_f32_dpp v113, v97, v97 row_half_mirror row_mask:0xf bank_mask:0xa
    v_add_f32_dpp v53, v37, v37 row_half_mirror row_mask:0xf bank_mask:0xa
    v_add_f32_dpp v117, v101, v101 row_half_mirror row_mask:0xf bank_mask:0xa
    v_cndmask_b32 v9, v41, v49, s[48:49]
    v_cndmask_b32 v13, v49, v41, s[48:49]
    v_cndmask_b32 v17, v45, v53, s[48:49]
    v_cndmask_b32 v21, v53, v45, s[48:49]
    v_cndmask_b32 v73, v105, v113, s[48:49]
    v_cndmask_b32 v77, v113, v105, s[48:49]
    v_cndmask_b32 v81, v109, v117, s[48:49]
    v_cndmask_b32 v85, v117, v109, s[48:49]
    v_add_f32_dpp v9, v13, v9 quad_perm:[2,3,0,1] row_mask:0xf bank_mask:0xf
    v_add_f32_dpp v17, v21, v17 quad_perm:[2,3,0,1] row_mask:0xf bank_mask:0xf
    v_add_f32_dpp v73, v77, v73 quad_perm:[2,3,0,1] row_mask:0xf bank_mask:0xf
    v_add_f32_dpp v81, v85, v81 quad_perm:[2,3,0,1] row_mask:0xf bank_mask:0xf
    v_cndmask_b32 v25, v9, v17, s[50:51]
    v_cndmask_b32 v29, v17, v9, s[50:51]
    v_cndmask_b32 v89, v73, v81, s[50:51]
    v_cndmask_b32 v93, v81, v73, s[50:51]
    v_add_f32_dpp v145, v29, v25 quad_perm:[1,0,3,2] row_mask:0xf bank_mask:0xf
    s_nop 0
    v_add_f32_dpp v146, v93, v89 quad_perm:[1,0,3,2] row_mask:0xf bank_mask:0xf
    v_cvt_pk_bf16_f32 v145, v145, v146
    v_and_b32 v146, 0xffff0000, v145
    v_lshlrev_b32 v145, 16, v145
    v_mul_f32 v146, 0x3db504f3, v146
    v_mul_f32 v145, 0x3db504f3, v145
    v_cvt_pk_bf16_f32 v145, v145, v146
    v_and_b32 v146, 0xffff0000, v145
    v_lshlrev_b32 v145, 16, v145
    v_max_f32 v8, v145, v146
    s_nop 1
    v_max_f32_dpp v8, v8, v8 row_ror:8 row_mask:0xf bank_mask:0xf
    s_nop 1
    v_max_f32_dpp v8, v8, v8 row_ror:4 row_mask:0xf bank_mask:0xf
    s_nop 1
    v_max_f32_dpp v8, v8, v8 row_ror:2 row_mask:0xf bank_mask:0xf
    s_nop 1
    v_max_f32_dpp v8, v8, v8 row_ror:1 row_mask:0xf bank_mask:0xf
    v_mov_b32 v147, v8
    s_nop 1
    v_permlane16_swap_b32 v8, v147
    v_max_f32 v8, v8, v147
    v_mov_b32 v147, v8
    s_nop 1
    v_permlane32_swap_b32 v8, v147
    v_max_f32 v8, v8, v147
    s_lshl_b32 s83, s86, 2
    v_mov_b32 v147, s83
    v_mov_b32 v148, 0
    ds_write_b32 v147, v8 offset:0
    s_mul_i32 s83, s86, 528
L_lm:
    ds_read_b128 v[8:11], v148 offset:0
    s_waitcnt lgkmcnt(0)
    v_max3_u32 v147, v8, v9, v10
    v_max_u32 v147, v147, v11
    v_cmp_eq_u32 vcc, -1, v147
    s_cbranch_vccz L_lm_ok
    s_sub_i32 s90, s90, 1
    s_cmp_lt_i32 s90, 0
    s_cbranch_scc0 L_lm
L_lm_ok:
    v_max3_f32 v8, v8, v9, v10
    v_max_f32 v8, v8, v11
    v_sub_f32 v145, v145, v8
    v_sub_f32 v146, v146, v8
    v_mul_f32 v145, 0x3fb8aa3b, v145
    v_mul_f32 v146, 0x3fb8aa3b, v146
    v_exp_f32 v145, v145
    v_exp_f32 v146, v146
    v_mul_f32 v8, 0x3eb8aa3b, v8
    v_mov_b32 v10, 0
    v_mov_b32 v11, 0
    v_add_f32 v9, v145, v146
    v_cvt_pk_bf16_f32 v12, v145, v145
    v_cvt_pk_bf16_f32 v13, v146, v146
    v_add_f32_dpp v9, v9, v9 row_ror:8 row_mask:0xf bank_mask:0xf
    s_nop 1
    v_add_f32_dpp v9, v9, v9 row_ror:4 row_mask:0xf bank_mask:0xf
    s_nop 1
    v_add_f32_dpp v9, v9, v9 row_ror:2 row_mask:0xf bank_mask:0xf
    s_nop 1
    v_add_f32_dpp v9, v9, v9 row_ror:1 row_mask:0xf bank_mask:0xf
    v_mov_b32 v147, v9
    s_nop 1
    v_permlane16_swap_b32 v9, v147
    v_add_f32 v9, v9, v147
    v_mov_b32 v147, v9
    s_nop 1
    v_permlane32_swap_b32 v9, v147
    v_add_f32 v9, v9, v147
    v_mov_b32 v145, s83
    s_mov_b64 exec, 1
    ds_write_b128 v145, v[8:11] offset:2880
    s_mov_b64 exec, -1
    ds_write_b64 v2, v[12:13] offset:320
    s_cmp_lt_u32 s2, 120
    s_cbranch_scc1 L_km
    s_cmp_lt_u32 s2, 128
    s_cbranch_scc1 L_kf
    v_and_b32 v149, 32, v1
    s_and_b32 s85, s86, 2
    s_lshl_b32 s84, s85, 13
    s_and_b32 s85, s86, 1
    s_lshl_b32 s85, s85, 6
    s_add_u32 s84, s84, s85
    s_add_u32 s84, s84, 8192
    v_and_b32 v145, 48, v1
    v_lshl_add_u32 v161, v145, 6, s84
    v_and_b32 v145, 12, v1
    v_lshl_add_u32 v161, v145, 5, v161
    v_and_b32 v145, 3, v1
    v_lshl_add_u32 v161, v145, 3, v161
    ds_read_b64_tr_b16 v[56:57], v161 offset:0
    ds_read_b64_tr_b16 v[58:59], v161 offset:512
    ds_read_b64_tr_b16 v[60:61], v161 offset:32
    ds_read_b64_tr_b16 v[62:63], v161 offset:544
    ds_read_b64_tr_b16 v[64:65], v161 offset:4096
    ds_read_b64_tr_b16 v[66:67], v161 offset:4608
    ds_read_b64_tr_b16 v[68:69], v161 offset:4128
    ds_read_b64_tr_b16 v[70:71], v161 offset:4640
    ds_read_b64_tr_b16 v[72:73], v161 offset:8192
    ds_read_b64_tr_b16 v[74:75], v161 offset:8704
    ds_read_b64_tr_b16 v[76:77], v161 offset:8224
    ds_read_b64_tr_b16 v[78:79], v161 offset:8736
    ds_read_b64_tr_b16 v[80:81], v161 offset:12288
    ds_read_b64_tr_b16 v[82:83], v161 offset:12800
    ds_read_b64_tr_b16 v[84:85], v161 offset:12320
    ds_read_b64_tr_b16 v[86:87], v161 offset:12832
    s_mul_i32 s83, s88, 6144
    s_add_u32 s83, s83, 262144
    v_bfe_u32 v145, v1, 2, 2
    v_and_b32 v146, 1, v1
    v_lshl_add_u32 v145, v145, 1, v146
    v_mul_u32_u24 v145, 768, v145
    v_and_b32 v146, 2, v1
    v_lshl_add_u32 v145, v146, 5, v145
    v_and_b32 v146, 48, v1
    v_add3_u32 v153, v145, v146, s83
    v_lshrrev_b32 v146, 3, v146
    v_add_u32 v146, v146, v1
    v_and_b32 v146, 7, v146
    v_mul_u32_u24 v146, 768, v146
    v_add_u32 v154, s83, v146
    v_and_b32 v146, 15, v1
    s_lshl_b32 s85, s85, 1
    v_lshl_add_u32 v155, v146, 2, s85
    v_lshl_add_u32 v155, v149, 1, v155
    v_and_b32 v146, 7, v1
    v_lshlrev_b32 v158, 5, v146
    v_mov_b32 v157, 1
    s_and_b32 s83, s2, 7
    s_lshl_b32 s83, s83, 10
    s_and_b32 s84, s2, 0x38
    s_lshl_b32 s84, s84, 4
    s_add_u32 s83, s83, s84
    s_and_b32 s84, s2, 0x40
    s_lshl_b32 s84, s84, 7
    s_add_u32 s83, s83, s84
    s_add_u32 s83, s83, 458752
    v_and_b32 v145, 7, v1
    v_lshl_add_u32 v156, v145, 4, s83
    v_and_b32 v145, 56, v1
    v_lshl_add_u32 v156, v145, 11, v156
    s_mov_b64 s[98:99], 0
    s_mov_b64 s[100:101], 0
    s_waitcnt lgkmcnt(0)
L_c1:
    s_mov_b64 exec, s[98:99]
    v_mfma_f32_16x16x32_bf16 v[104:107], v[12:15], v[56:59], 0
    v_max_f32_dpp v22, v20, v20 row_ror:4 row_mask:0xf bank_mask:0xf
    v_mfma_f32_16x16x32_bf16 v[108:111], v[12:15], v[64:67], 0
    s_nop 0
    v_max_f32_dpp v22, v22, v22 row_ror:2 row_mask:0xf bank_mask:0xf
    v_mfma_f32_16x16x32_bf16 v[112:115], v[12:15], v[60:63], 0
    s_nop 0
    v_max_f32_dpp v22, v22, v22 row_ror:1 row_mask:0xf bank_mask:0xf
    v_sub_f32 v22, v20, v22
    v_exp_f32 v22, v22
    v_mfma_f32_16x16x32_bf16 v[116:119], v[12:15], v[68:71], 0
    v_mul_f32 v23, v22, v21
    v_mfma_f32_16x16x32_bf16 v[104:107], v[16:19], v[72:75], v[104:107]
    s_nop 0
    v_add_f32_dpp v23, v23, v23 row_ror:4 row_mask:0xf bank_mask:0xf
    v_mfma_f32_16x16x32_bf16 v[108:111], v[16:19], v[80:83], v[108:111]
    s_nop 0
    v_add_f32_dpp v23, v23, v23 row_ror:2 row_mask:0xf bank_mask:0xf
    v_mfma_f32_16x16x32_bf16 v[112:115], v[16:19], v[76:79], v[112:115]
    s_nop 0
    v_add_f32_dpp v23, v23, v23 row_ror:1 row_mask:0xf bank_mask:0xf
    v_rcp_f32 v23, v23
    v_mfma_f32_16x16x32_bf16 v[116:119], v[16:19], v[84:87], v[116:119]
    v_mul_f32 v22, v22, v23
    v_pk_add_f32 v[104:105], v[104:105], v[110:111]
    s_nop 1
    v_mul_f32_dpp v145, v22, v104 row_newbcast:0 row_mask:0xf bank_mask:0xf
    s_nop 1
    v_fmac_f32_dpp v145, v22, v105 row_newbcast:1 row_mask:0xf bank_mask:0xf
    v_pk_add_f32 v[112:113], v[112:113], v[118:119]
    s_nop 1
    v_mul_f32_dpp v146, v22, v112 row_newbcast:0 row_mask:0xf bank_mask:0xf
    s_nop 1
    v_fmac_f32_dpp v146, v22, v113 row_newbcast:1 row_mask:0xf bank_mask:0xf
    s_nop 1
    v_permlane32_swap_b32 v145, v146
    v_add_f32 v145, v145, v146
    ds_add_f32 v155, v145 offset:4608
    s_mov_b64 exec, s[100:101]
    ds_add_rtn_u32 v147, v148, v157 offset:36
    s_mov_b64 exec, s[98:99]
    ds_read_b128 v[104:107], v158 offset:4608
    ds_read_b128 v[108:111], v158 offset:4624
    s_waitcnt lgkmcnt(0)
    v_readfirstlane_b32 s83, v147
    v_cvt_pk_bf16_f32 v104, v104, v105
    v_cvt_pk_bf16_f32 v105, v106, v107
    v_cvt_pk_bf16_f32 v106, v108, v109
    v_cvt_pk_bf16_f32 v107, v110, v111
    s_cmp_eq_u32 s83, 2
    s_cselect_b64 exec, s[98:99], 0
    buffer_store_dwordx4 v[104:107], v156, s[32:35], 0 offen sc1
    s_cmp_lg_u32 s98, 0
    s_cbranch_scc1 L_fin
    s_mov_b64 exec, -1
    s_mov_b64 s[98:99], -1
    s_mov_b64 s[100:101], 1
    s_waitcnt vmcnt(0)
L_qc1:
    v_cmp_ne_u32 vcc, s94, v150
    s_cbranch_vccz L_qc1_ok
    buffer_load_dwordx2 v[150:151], v3, s[32:35], 0 offen offset:8 sc1
    s_waitcnt vmcnt(0)
    s_sub_i32 s90, s90, 1
    s_cmp_lt_i32 s90, 0
    s_cbranch_scc0 L_qc1
L_qc1_ok:
    v_cmp_ne_u32 vcc, s95, v151
    s_cmp_eq_u64 vcc, 0
    s_cselect_b32 s91, 0, 384
L_lv1:
    ds_read_b128 v[8:11], v148 offset:16
    s_waitcnt lgkmcnt(0)
    v_max3_u32 v147, v8, v9, v10
    v_max_u32 v147, v147, v11
    v_cmp_eq_u32 vcc, -1, v147
    s_cbranch_vccz L_lv1_ok
    s_sub_i32 s90, s90, 1
    s_cmp_lt_i32 s90, 0
    s_cbranch_scc0 L_lv1
L_lv1_ok:
    s_setprio 2
L_p1:
    buffer_load_dwordx2 v[20:21], v154, s[32:35], s91 offen offset:256 sc1
    buffer_load_dwordx4 v[12:15], v153, s[32:35], s91 offen sc1
    buffer_load_dwordx4 v[16:19], v153, s[32:35], s91 offen offset:128 sc1
    s_waitcnt vmcnt(0)
    v_max3_u32 v145, v12, v13, v14
    v_max3_u32 v146, v15, v16, v17
    v_max3_u32 v145, v145, v18, v19
    v_max3_u32 v146, v146, v20, v21
    v_max_u32 v145, v145, v146
    v_cmp_eq_u32 vcc, -1, v145
    s_and_b64 exec, vcc, vcc
    s_cbranch_scc0 L_c1
    s_sub_i32 s90, s90, 1
    s_cmp_lt_i32 s90, 0
    s_cbranch_scc0 L_p1
L_p1_ok:
    s_branch L_c1
L_km:
    s_cmp_eq_u32 s86, 0
    s_cbranch_scc0 L_kt
L_lt:
    ds_read_b128 v[8:11], v148 offset:48
    s_waitcnt lgkmcnt(0)
    v_max3_u32 v147, v8, v9, v10
    v_max_u32 v147, v147, v11
    v_cmp_eq_u32 vcc, -1, v147
    s_cbranch_vccz L_lt_ok
    s_sub_i32 s90, s90, 1
    s_cmp_lt_i32 s90, 0
    s_cbranch_scc0 L_lt
L_lt_ok:
    v_mov_b32 v147, 119
    s_mov_b64 exec, 1
    global_atomic_inc v147, v148, v147, s[78:79] sc0 sc1
    s_waitcnt vmcnt(0)
    v_min_u32 v147, 119, v147
    ds_write_b32 v148, v147 offset:40
    s_mov_b64 exec, -1
L_kt:
L_r1:
    ds_read_b32 v8, v148 offset:40
    s_waitcnt lgkmcnt(0)
    v_cmp_eq_u32 vcc, -1, v8
    s_cbranch_vccz L_r1_ok
    s_sub_i32 s90, s90, 1
    s_cmp_lt_i32 s90, 0
    s_cbranch_scc0 L_r1
L_r1_ok:
    v_readfirstlane_b32 s87, v8
    s_cmp_ge_u32 s87, 43
    s_cbranch_scc1 L_fin
    s_mov_b64 s[40:41], s[68:69]
    s_mov_b64 s[44:45], s[72:73]
    s_mov_b32 s42, 1409024
    s_mov_b32 s43, 0x20000
    s_mov_b32 s46, 1409024
    s_mov_b32 s47, 0x20000
    v_lshrrev_b32 v145, 3, v1
    v_and_b32 v146, 6, v145
    v_xor_b32 v146, v146, v1
    v_and_b32 v146, 7, v146
    v_lshlrev_b32 v152, 4, v146
    v_and_b32 v146, 3, v145
    v_lshl_add_u32 v152, v146, 10, v152
    v_lshrrev_b32 v146, 2, v145
    v_lshl_add_u32 v152, v146, 13, v152
    v_and_b32 v146, 2, v145
    v_xor_b32 v146, v146, v1
    v_and_b32 v146, 3, v146
    v_lshrrev_b32 v145, 2, v1
    v_mul_u32_u24 v145, 2752, v145
    v_lshl_add_u32 v153, v146, 4, v145
    s_mul_i32 s83, s86, 352256
    s_lshl_b32 s84, s87, 6
    s_add_u32 s83, s83, s84
    s_lshl_b32 s84, s86, 13
    s_add_u32 m0, s84, 8192
L_lv2:
    s_nop 0
    ds_read_b128 v[8:11], v148 offset:16
    s_waitcnt lgkmcnt(0)
    v_max3_u32 v147, v8, v9, v10
    v_max_u32 v147, v147, v11
    v_cmp_eq_u32 vcc, -1, v147
    s_cbranch_vccz L_lv2_ok
    s_sub_i32 s90, s90, 1
    s_cmp_lt_i32 s90, 0
    s_cbranch_scc0 L_lv2
L_lv2_ok:
    buffer_load_dwordx4 v153, s[40:43], s83 offen lds
    s_add_u32 m0, m0, 1024
    s_add_u32 s83, s83, 44032
    buffer_load_dwordx4 v153, s[40:43], s83 offen lds
    s_add_u32 m0, m0, 1024
    s_add_u32 s83, s83, 44032
    buffer_load_dwordx4 v153, s[40:43], s83 offen lds
    s_add_u32 m0, m0, 1024
    s_add_u32 s83, s83, 44032
    buffer_load_dwordx4 v153, s[40:43], s83 offen lds
    s_add_u32 m0, m0, 1024
    s_add_u32 s83, s83, 44032
    buffer_load_dwordx4 v153, s[40:43], s83 offen lds
    s_add_u32 m0, m0, 1024
    s_add_u32 s83, s83, 44032
    buffer_load_dwordx4 v153, s[40:43], s83 offen lds
    s_add_u32 m0, m0, 1024
    s_add_u32 s83, s83, 44032
    buffer_load_dwordx4 v153, s[40:43], s83 offen lds
    s_add_u32 m0, m0, 1024
    s_add_u32 s83, s83, 44032
    buffer_load_dwordx4 v153, s[40:43], s83 offen lds
    s_lshl_b32 s83, s87, 15
    s_lshl_b32 s85, s86, 8
    s_add_u32 s83, s83, s85
    s_add_u32 m0, s84, 40960
L_lv2b:
    s_nop 0
    ds_read_b32 v8, v148 offset:32
    s_waitcnt lgkmcnt(0)
    v_cmp_eq_u32 vcc, -1, v8
    s_cbranch_vccz L_lv2b_ok
    s_sub_i32 s90, s90, 1
    s_cmp_lt_i32 s90, 0
    s_cbranch_scc0 L_lv2b
L_lv2b_ok:
    buffer_load_dwordx4 v152, s[44:47], s83 offen nt lds
    s_add_u32 m0, m0, 1024
    s_add_u32 s83, s83, 4096
    buffer_load_dwordx4 v152, s[44:47], s83 offen nt lds
    s_add_u32 m0, m0, 1024
    s_add_u32 s83, s83, 12288
    buffer_load_dwordx4 v152, s[44:47], s83 offen nt lds
    s_add_u32 m0, m0, 1024
    s_add_u32 s83, s83, 4096
    buffer_load_dwordx4 v152, s[44:47], s83 offen nt lds
    s_add_u32 m0, m0, 1024
    s_sub_u32 s83, s83, 20352
    buffer_load_dwordx4 v152, s[44:47], s83 offen nt lds
    s_add_u32 m0, m0, 1024
    s_add_u32 s83, s83, 4096
    buffer_load_dwordx4 v152, s[44:47], s83 offen nt lds
    s_add_u32 m0, m0, 1024
    s_add_u32 s83, s83, 12288
    buffer_load_dwordx4 v152, s[44:47], s83 offen nt lds
    s_add_u32 m0, m0, 1024
    s_add_u32 s83, s83, 4096
    buffer_load_dwordx4 v152, s[44:47], s83 offen nt lds
    s_lshl_b32 s83, s87, 6
    v_and_b32 v145, 7, v1
    v_and_b32 v146, 48, v1
    v_lshl_add_u32 v145, v145, 1, s83
    v_add_u32 v145, v145, v146
    global_load_ushort v144, v145, s[70:71]
    s_waitcnt vmcnt(17)
L_qc2:
    v_cmp_ne_u32 vcc, s94, v150
    s_cbranch_vccz L_qc2_ok
    buffer_load_dwordx2 v[150:151], v3, s[32:35], 0 offen offset:8 sc1
    s_waitcnt vmcnt(0)
    s_sub_i32 s90, s90, 1
    s_cmp_lt_i32 s90, 0
    s_cbranch_scc0 L_qc2
L_qc2_ok:
L_mlp0:
    s_and_b32 s84, s2, 7
    s_lshl_b32 s84, s84, 14
    s_lshl_b32 s83, s89, 7
    s_add_u32 s84, s84, s83
    s_add_u32 s84, s84, 458752
    s_mov_b32 s92, 8192
    v_lshrrev_b32 v145, 3, v1
    v_lshl_add_u32 v160, v145, 10, s84
    v_and_b32 v146, 7, v1
    v_lshl_add_u32 v160, v146, 4, v160
    v_and_b32 v146, 7, v1
    s_lshl_b32 s83, s89, 7
    s_lshl_b32 s84, s87, 10
    s_add_u32 s83, s83, s84
    s_add_u32 s83, s83, 590848
    v_and_b32 v147, 48, v1
    v_add_u32 v167, s83, v147
    v_and_b32 v148, 8, v1
    v_lshl_add_u32 v167, v148, 3, v167
    v_lshlrev_b32 v166, 2, v148
    v_lshlrev_b32 v165, 7, v148
    v_lshl_add_u32 v165, v147, 4, v165
    v_lshl_add_u32 v165, v146, 5, v165
    s_lshl_b32 s83, s89, 2
    v_and_b32 v149, 32, v1
    v_add_u32 v164, v166, v149
    v_add_u32 v164, s83, v164
    s_add_u32 s83, s83, 4864
    v_lshl_add_u32 v163, v149, 5, s83
    v_and_b32 v104, 15, v1
    v_lshl_add_u32 v163, v104, 5, v163
    s_lshl_b32 s83, s89, 12
    s_add_u32 s84, s83, 8192
    v_bfe_u32 v145, v1, 2, 3
    v_and_b32 v146, 3, v1
    v_lshl_add_u32 v161, v149, 6, s84
    v_lshl_add_u32 v161, v145, 6, v161
    v_lshl_add_u32 v161, v146, 3, v161
    v_and_b32 v147, 16, v1
    v_lshl_add_u32 v161, v147, 1, v161
    v_xor_b32 v138, 32, v161
    s_add_u32 s84, s83, 40960
    v_lshl_add_u32 v162, v149, 6, s84
    v_lshl_add_u32 v162, v145, 7, v162
    v_and_b32 v147, 6, v145
    v_xor_b32 v147, v147, v146
    v_lshl_add_u32 v162, v147, 4, v162
    v_xor_b32 v139, 64, v162
    v_mov_b32 v88, 0x3f803f80
    v_mov_b32 v96, 0
    v_mov_b32 v89, 0x3f803f80
    v_mov_b32 v97, 0
    v_mov_b32 v90, 0x3f803f80
    v_mov_b32 v98, 0
    v_mov_b32 v91, 0x3f803f80
    v_mov_b32 v99, 0
    v_mov_b32 v92, 0x3f803f80
    v_mov_b32 v100, 0
    v_mov_b32 v93, 0x3f803f80
    v_mov_b32 v101, 0
    v_mov_b32 v94, 0x3f803f80
    v_mov_b32 v102, 0
    v_mov_b32 v95, 0x3f803f80
    v_mov_b32 v103, 0
    v_and_b32 v4, 0x3f803f80, v4
    v_and_b32 v5, 0x3f803f80, v5
    v_and_b32 v6, 0x3f803f80, v6
    v_and_b32 v7, 0x3f803f80, v7
    v_lshlrev_b32 v120, 16, v140
    v_and_b32 v121, 0xffff0000, v140
    v_lshlrev_b32 v122, 16, v141
    v_and_b32 v123, 0xffff0000, v141
    v_mul_f32 v120, 0.5, v120
    v_mul_f32 v121, 0.5, v121
    v_mul_f32 v122, 0.5, v122
    v_mul_f32 v123, 0.5, v123
    s_mov_b64 s[98:99], -1
    s_mov_b32 s100, 0x01010101
    s_mov_b32 s101, 0x01010101
    s_waitcnt vmcnt(0)
    v_lshlrev_b32 v144, 16, v144
    s_setprio 2
    s_barrier
L_mlp:
    ds_read_b64_tr_b16 v[56:57], v161 offset:0
    ds_read_b64_tr_b16 v[58:59], v161 offset:512
    ds_read_b64_tr_b16 v[60:61], v138 offset:0
    ds_read_b64_tr_b16 v[62:63], v138 offset:512
    ds_read_b64_tr_b16 v[64:65], v161 offset:1024
    ds_read_b64_tr_b16 v[66:67], v161 offset:1536
    ds_read_b64_tr_b16 v[68:69], v138 offset:1024
    ds_read_b64_tr_b16 v[70:71], v138 offset:1536
    ds_read_b64_tr_b16 v[72:73], v162 offset:0
    ds_read_b64_tr_b16 v[74:75], v162 offset:1024
    ds_read_b64_tr_b16 v[76:77], v162 offset:8
    ds_read_b64_tr_b16 v[78:79], v162 offset:1032
    ds_read_b64_tr_b16 v[80:81], v139 offset:0
    ds_read_b64_tr_b16 v[82:83], v139 offset:1024
    ds_read_b64_tr_b16 v[84:85], v139 offset:8
    ds_read_b64_tr_b16 v[86:87], v139 offset:1032
L_p2:
    buffer_load_dwordx4 v[24:27], v160, s[32:35], 0 offen sc1
    buffer_load_dwordx4 v[28:31], v160, s[32:35], s92 offen sc1
    s_waitcnt vmcnt(0)
    v_max3_u32 v145, v24, v25, v26
    v_max3_u32 v146, v27, v28, v29
    v_max3_u32 v145, v145, v30, v31
    v_max_u32 v146, v146, v145
    v_cmp_eq_u32 vcc, -1, v146
    s_and_b64 exec, vcc, vcc
    s_cbranch_scc0 L_p2_ok
    s_sub_i32 s90, s90, 1
    s_cmp_lt_i32 s90, 0
    s_cbranch_scc0 L_p2
L_p2_ok:
    s_mov_b64 exec, s[98:99]
    v_mfma_f32_16x16x32_bf16 v[104:107], v[4:7], v[24:27], v[120:123]
    v_mfma_f32_16x16x32_bf16 v[104:107], v[4:7], v[28:31], v[104:107]
    s_nop 7
    v_add_f32_dpp v104, v104, v104 row_ror:8 row_mask:0xf bank_mask:0xf
    v_add_f32_dpp v105, v105, v105 row_ror:8 row_mask:0xf bank_mask:0xf
    v_add_f32_dpp v106, v106, v106 row_ror:8 row_mask:0xf bank_mask:0xf
    v_add_f32_dpp v107, v107, v107 row_ror:8 row_mask:0xf bank_mask:0xf
    v_cvt_pk_bf16_f32 v124, v104, v105
    v_cvt_pk_bf16_f32 v125, v106, v107
    s_nop 0
    v_mov_b32_dpp v124, v124 row_ror:4 row_mask:0xc bank_mask:0xf
    v_mov_b32_dpp v125, v125 row_ror:4 row_mask:0xc bank_mask:0xf
    s_nop 0
    v_mov_b32_dpp v88, v124 row_newbcast:0 row_mask:0xf bank_mask:0x3
    v_mov_b32_dpp v89, v125 row_newbcast:0 row_mask:0xf bank_mask:0x3
    v_mov_b32_dpp v90, v124 row_newbcast:1 row_mask:0xf bank_mask:0x3
    v_mov_b32_dpp v91, v125 row_newbcast:1 row_mask:0xf bank_mask:0x3
    v_mov_b32_dpp v92, v124 row_newbcast:2 row_mask:0xf bank_mask:0x3
    v_mov_b32_dpp v93, v125 row_newbcast:2 row_mask:0xf bank_mask:0x3
    v_mov_b32_dpp v94, v124 row_newbcast:3 row_mask:0xf bank_mask:0x3
    v_mov_b32_dpp v95, v125 row_newbcast:3 row_mask:0xf bank_mask:0x3
    s_waitcnt lgkmcnt(0)
    v_mfma_f32_16x16x32_bf16 v[112:115], v[88:91], v[88:91], 0
    v_mfma_f32_16x16x32_bf16 v[104:107], v[88:91], v[56:59], 0
    v_mfma_f32_16x16x32_bf16 v[108:111], v[88:91], v[60:63], 0
    v_mfma_f32_16x16x32_bf16 v[112:115], v[92:95], v[92:95], v[112:115]
    v_mfma_f32_16x16x32_bf16 v[104:107], v[92:95], v[64:67], v[104:107]
    v_mfma_f32_16x16x32_bf16 v[108:111], v[92:95], v[68:71], v[108:111]
    s_nop 5
    ds_write_b32 v164, v112 offset:6912
    s_nop 0
    ds_write2_b32 v163, v104, v108 offset0:0 offset1:128
    s_waitcnt lgkmcnt(0)
    s_barrier
    ds_read_b128 v[8:11], v166 offset:6912
    ds_read_b128 v[12:15], v166 offset:6928
    ds_read_b128 v[16:19], v165 offset:4864
    ds_read_b128 v[20:23], v165 offset:4880
    s_waitcnt lgkmcnt(2)
    v_pk_add_f32 v[8:9], v[8:9], v[12:13]
    v_pk_add_f32 v[10:11], v[10:11], v[14:15]
    v_pk_add_f32 v[8:9], v[8:9], v[10:11]
    v_add_f32 v146, v8, v9
    s_waitcnt lgkmcnt(0)
    v_pk_add_f32 v[16:17], v[16:17], v[20:21]
    v_pk_add_f32 v[18:19], v[18:19], v[22:23]
    v_mul_f32 v146, 0x3b000000, v146
    v_pk_add_f32 v[16:17], v[16:17], v[18:19]
    s_nop 0
    v_mov_b32_dpp v145, v146 row_ror:8 row_mask:0xf bank_mask:0xf
    v_add_f32 v147, v16, v17
    v_fma_f32 v146, -v145, v145, v146
    v_max_f32 v146, 0, v146
    v_mov_b32_dpp v148, v147 row_ror:8 row_mask:0xf bank_mask:0xf
    v_cvt_pk_bf16_f32 v149, v145, v145
    v_and_b32 v149, 0xffff0000, v149
    v_cvt_pk_bf16_f32 v150, v146, v146
    v_and_b32 v150, 0xffff0000, v150
    v_add_f32 v150, 0x3727c5ac, v150
    v_cvt_pk_bf16_f32 v150, v150, v150
    v_and_b32 v150, 0xffff0000, v150
    v_sqrt_f32 v150, v150
    v_sub_f32 v145, v145, v149
    v_cvt_pk_bf16_f32 v150, v150, v150
    v_and_b32 v150, 0xffff0000, v150
    v_rcp_f32 v151, v150
    s_nop 0
    v_mul_f32 v146, v146, v151
    v_mul_f32 v145, v145, v151
    v_mul_f32 v146, v146, v151
    v_cvt_pk_bf16_f32 v145, v145, v145
    v_and_b32 v145, 0xffff0000, v145
    v_cvt_pk_bf16_f32 v146, v146, v146
    v_and_b32 v146, 0xffff0000, v146
    v_add_f32 v146, 0x3727c5ac, v146
    v_fmac_f32 v149, v145, v150
    v_cvt_pk_bf16_f32 v146, v146, v146
    v_and_b32 v146, 0xffff0000, v146
    v_sqrt_f32 v146, v146
    v_fma_f32 v147, -v149, v148, v147
    v_cvt_pk_bf16_f32 v146, v146, v146
    v_and_b32 v146, 0xffff0000, v146
    v_rcp_f32 v146, v146
    v_mul_f32 v147, v147, v151
    v_mul_f32 v147, v147, v146
    v_cvt_pk_bf16_f32 v147, v147, v147
    v_and_b32 v147, 0xffff0000, v147
    v_add_f32 v147, v147, v144
    v_cvt_pk_bf16_f32 v147, v147, v147
    v_and_b32 v147, 0xffff0000, v147
    v_mul_f32 v145, v147, v147
    v_mov_b32 v146, 0xc0135761
    v_fmac_f32 v146, 0xbdd2d3e8, v145
    v_mul_f32 v145, v146, v147
    v_exp_f32 v145, v145
    s_nop 0
    v_add_f32 v145, 1.0, v145
    v_rcp_f32 v145, v145
    s_nop 0
    v_mul_f32 v145, v145, v147
    s_nop 1
    v_mov_b32_dpp v146, v145 quad_perm:[1,0,3,2] row_mask:0xf bank_mask:0xf
    v_cvt_pk_bf16_f32 v145, v145, v146
    s_nop 1
    v_mov_b32_dpp v96, v145 row_newbcast:0 row_mask:0xf bank_mask:0x3
    v_mov_b32_dpp v97, v145 row_newbcast:2 row_mask:0xf bank_mask:0x3
    v_mov_b32_dpp v98, v145 row_newbcast:4 row_mask:0xf bank_mask:0x3
    v_mov_b32_dpp v99, v145 row_newbcast:6 row_mask:0xf bank_mask:0x3
    v_mov_b32_dpp v100, v145 row_newbcast:0 row_mask:0xf bank_mask:0xc
    v_mov_b32_dpp v101, v145 row_newbcast:2 row_mask:0xf bank_mask:0xc
    v_mov_b32_dpp v102, v145 row_newbcast:4 row_mask:0xf bank_mask:0xc
    v_mov_b32_dpp v103, v145 row_newbcast:6 row_mask:0xf bank_mask:0xc
    v_mfma_f32_16x16x32_bf16 v[104:107], v[72:75], v[96:99], 0
    v_mfma_f32_16x16x32_bf16 v[108:111], v[76:79], v[96:99], 0
    v_mfma_f32_16x16x32_bf16 v[104:107], v[80:83], v[100:103], v[104:107]
    v_mfma_f32_16x16x32_bf16 v[108:111], v[84:87], v[100:103], v[108:111]
    s_mov_b64 exec, s[100:101]
    s_nop 5
    v_cvt_pk_bf16_f32 v104, v104, v105
    v_cvt_pk_bf16_f32 v105, v106, v107
    v_cvt_pk_bf16_f32 v106, v108, v109
    v_cvt_pk_bf16_f32 v107, v110, v111
    buffer_store_dwordx4 v[104:107], v167, s[32:35], 0 offen sc1
    s_mov_b64 exec, s[98:99]
    s_lshl_b32 s83, s82, 8
    s_add_u32 s83, s83, s87
    s_cmp_eq_u32 s83, 256
    s_cbranch_scc0 L_fin
    v_mov_b32 v145, 589824
    v_mov_b32 v146, s94
    s_mov_b64 exec, 1
    buffer_store_dword v146, v145, s[32:35], 0 offen sc1
    s_branch L_fin
L_kf:
    s_and_b32 s83, s2, 0xf8
    s_lshl_b32 s84, s86, 8
    s_add_u32 s83, s83, s84
    s_cmp_eq_u32 s83, 120
    s_cbranch_scc0 L_fin
    s_and_b32 s84, s2, 7
    s_lshl_b32 s84, s84, 14
    s_lshl_b32 s83, s89, 7
    s_add_u32 s84, s84, s83
    s_add_u32 s84, s84, 458752
    s_mov_b32 s92, 8192
    v_lshrrev_b32 v145, 3, v1
    v_lshl_add_u32 v164, v145, 10, s84
    v_and_b32 v146, 7, v1
    v_lshl_add_u32 v164, v146, 4, v164
    s_lshl_b32 s83, s89, 7
    v_and_b32 v146, 7, v1
    v_lshl_add_u32 v166, v146, 4, s83
    v_lshl_add_u32 v165, v145, 10, v166
    v_add_u32 v165, 590848, v165
    v_bfe_u32 v146, v1, 4, 1
    v_lshl_add_u32 v166, v146, 3, v166
    v_subrev_u32 v145, 16, v1
    v_min_u32 v145, 42, v145
    v_and_b32 v146, 31, v145
    v_lshrrev_b32 v145, 5, v145
    v_lshl_add_u32 v145, v146, 3, v145
    v_add_lshl_u32 v3, v145, 4, 10
    s_and_b32 s83, s89, 3
    s_lshl_b32 s83, s83, 6
    s_lshr_b32 s84, s89, 2
    s_add_u32 s83, s83, s84
    s_add_u32 s83, s83, 4
    s_lshl_b32 s83, s83, 10
    s_mov_b64 exec, 0xffff
    v_and_b32 v145, 7, v1
    v_lshl_add_u32 v3, v145, 13, s83
    v_and_b32 v145, 8, v1
    v_lshl_add_u32 v3, v145, 8, v3
    s_mov_b64 exec, -1
    v_and_b32 v4, 0x3f803f80, v4
    v_and_b32 v5, 0x3f803f80, v5
    v_and_b32 v6, 0x3f803f80, v6
    v_and_b32 v7, 0x3f803f80, v7
    s_mov_b32 s41, 8192
    s_mov_b32 s42, 16384
    s_mov_b32 s43, 24576
    s_mov_b32 s44, 32768
    s_mov_b32 s45, 40960
    s_mov_b64 s[30:31], 0
L_fx:
    s_mov_b64 exec, -1
    v_mfma_f32_16x16x32_bf16 v[156:159], v[4:7], v[16:19], 0
    v_mfma_f32_16x16x32_bf16 v[152:155], v[4:7], v[20:23], v[160:163]
    v_mfma_f32_16x16x32_bf16 v[156:159], v[4:7], v[24:27], v[156:159]
    v_mfma_f32_16x16x32_bf16 v[152:155], v[4:7], v[28:31], v[152:155]
    v_mfma_f32_16x16x32_bf16 v[156:159], v[4:7], v[32:35], v[156:159]
    v_mfma_f32_16x16x32_bf16 v[152:155], v[4:7], v[36:39], v[152:155]
    s_nop 7
    v_pk_add_f32 v[152:153], v[152:153], v[156:157]
    v_pk_add_f32 v[154:155], v[154:155], v[158:159]
    s_nop 0
    v_add_f32_dpp v152, v152, v152 row_ror:8 row_mask:0xf bank_mask:0xf
    v_add_f32_dpp v153, v153, v153 row_ror:8 row_mask:0xf bank_mask:0xf
    v_add_f32_dpp v154, v154, v154 row_ror:8 row_mask:0xf bank_mask:0xf
    v_add_f32_dpp v155, v155, v155 row_ror:8 row_mask:0xf bank_mask:0xf
    s_mov_b64 exec, s[30:31]
    v_cvt_pk_bf16_f32 v152, v152, v153
    v_cvt_pk_bf16_f32 v153, v154, v155
    global_store_dwordx2 v166, v[152:153], s[76:77]
    s_cbranch_execnz L_fin
    s_mov_b64 exec, -1
    s_mov_b32 s30, 0x00ff00ff
    v_lshlrev_b32 v156, 16, v140
    v_and_b32 v157, 0xffff0000, v140
    v_lshlrev_b32 v158, 16, v141
    v_and_b32 v159, 0xffff0000, v141
    v_mul_f32 v156, 0.5, v156
    v_mul_f32 v157, 0.5, v157
    v_mul_f32 v158, 0.5, v158
    v_mul_f32 v159, 0.5, v159
    v_lshlrev_b32 v160, 16, v142
    v_and_b32 v161, 0xffff0000, v142
    v_lshlrev_b32 v162, 16, v143
    v_and_b32 v163, 0xffff0000, v143
L_lv3:
    ds_read_b128 v[8:11], v148 offset:16
    s_waitcnt lgkmcnt(0)
    v_max3_u32 v147, v8, v9, v10
    v_max_u32 v147, v147, v11
    v_cmp_eq_u32 vcc, -1, v147
    s_cbranch_vccz L_lv3_ok
    s_sub_i32 s90, s90, 1
    s_cmp_lt_i32 s90, 0
    s_cbranch_scc0 L_lv3
L_lv3_ok:
    buffer_load_dwordx2 v[150:151], v3, s[32:35], 0 offen offset:8 sc1
    s_waitcnt vmcnt(0)
L_qc3:
    v_cmp_ne_u32 vcc, s94, v150
    s_cbranch_vccz L_qc3_ok
    buffer_load_dwordx2 v[150:151], v3, s[32:35], 0 offen offset:8 sc1
    s_waitcnt vmcnt(0)
    s_sub_i32 s90, s90, 1
    s_cmp_lt_i32 s90, 0
    s_cbranch_scc0 L_qc3
L_qc3_ok:
    s_setprio 2
    buffer_load_dwordx4 v[16:19], v165, s[32:35], 0 offen sc1
    buffer_load_dwordx4 v[20:23], v165, s[32:35], s41 offen sc1
    buffer_load_dwordx4 v[24:27], v165, s[32:35], s42 offen sc1
    buffer_load_dwordx4 v[28:31], v165, s[32:35], s43 offen sc1
    buffer_load_dwordx4 v[32:35], v165, s[32:35], s44 offen sc1
    buffer_load_dwordx4 v[36:39], v165, s[32:35], s45 offen sc1
L_f2:
    buffer_load_dwordx4 v[104:107], v164, s[32:35], 0 offen sc1
    buffer_load_dwordx4 v[108:111], v164, s[32:35], s92 offen sc1
    s_waitcnt vmcnt(0)
    v_max3_u32 v145, v104, v105, v106
    v_max3_u32 v146, v107, v108, v109
    v_max3_u32 v145, v145, v110, v111
    v_max_u32 v146, v146, v145
    v_cmp_eq_u32 vcc, -1, v146
    s_and_b64 exec, vcc, vcc
    s_cbranch_scc0 L_f2_ok
    s_sub_i32 s90, s90, 1
    s_cmp_lt_i32 s90, 0
    s_cbranch_scc0 L_f2
L_f2_ok:
    s_mov_b64 exec, -1
    v_mfma_f32_16x16x32_bf16 v[152:155], v[4:7], v[104:107], v[156:159]
    v_mfma_f32_16x16x32_bf16 v[152:155], v[4:7], v[108:111], v[152:155]
    s_nop 7
    v_add_f32_dpp v152, v152, v152 row_ror:8 row_mask:0xf bank_mask:0xf
    v_add_f32_dpp v153, v153, v153 row_ror:8 row_mask:0xf bank_mask:0xf
    v_add_f32_dpp v154, v154, v154 row_ror:8 row_mask:0xf bank_mask:0xf
    v_add_f32_dpp v155, v155, v155 row_ror:8 row_mask:0xf bank_mask:0xf
    v_cvt_pk_bf16_f32 v152, v152, v153
    v_cvt_pk_bf16_f32 v153, v154, v155
    v_lshlrev_b32 v156, 16, v152
    v_and_b32 v157, 0xffff0000, v152
    v_lshlrev_b32 v158, 16, v153
    v_and_b32 v159, 0xffff0000, v153
    v_add_f32 v160, v160, v156
    v_add_f32 v161, v161, v157
    v_add_f32 v162, v162, v158
    v_add_f32 v163, v163, v159
    v_mul_f32 v160, 0.5, v160
    v_mul_f32 v161, 0.5, v161
    v_mul_f32 v162, 0.5, v162
    v_mul_f32 v163, 0.5, v163
L_p3:
    buffer_load_dwordx4 v[16:19], v165, s[32:35], 0 offen sc1
    buffer_load_dwordx4 v[20:23], v165, s[32:35], s41 offen sc1
    buffer_load_dwordx4 v[24:27], v165, s[32:35], s42 offen sc1
    buffer_load_dwordx4 v[28:31], v165, s[32:35], s43 offen sc1
    buffer_load_dwordx4 v[32:35], v165, s[32:35], s44 offen sc1
    buffer_load_dwordx4 v[36:39], v165, s[32:35], s45 offen sc1
    s_waitcnt vmcnt(0)
    v_max3_u32 v145, v16, v17, v18
    v_max3_u32 v146, v19, v20, v21
    v_max3_u32 v147, v22, v23, v24
    v_max3_u32 v145, v145, v25, v26
    v_max3_u32 v146, v146, v27, v28
    v_max3_u32 v147, v147, v29, v30
    v_max3_u32 v145, v145, v31, v32
    v_max3_u32 v146, v146, v33, v34
    v_max3_u32 v147, v147, v35, v36
    v_max3_u32 v145, v145, v37, v38
    v_max3_u32 v146, v146, v39, v147
    v_max_u32 v147, v145, v146
    v_cmp_eq_u32 vcc, -1, v147
    s_and_b64 exec, vcc, vcc
    s_cbranch_scc0 L_fx
    s_sub_i32 s90, s90, 1
    s_cmp_lt_i32 s90, 0
    s_cbranch_scc0 L_p3
L_p3_ok:
    s_branch L_fx
L_V:
    v_and_b32 v146, 1, v1
    v_lshlrev_b32 v146, 4, v146
    v_mov_b32 v147, 0xffff
    v_lshlrev_b32 v146, v146, v147
    v_bfe_u32 v147, v1, 1, 2
    v_cmp_eq_u32 vcc, 0, v147
    s_nop 1
    v_cndmask_b32 v4, 0, v146, vcc
    v_cmp_eq_u32 vcc, 1, v147
    s_nop 1
    v_cndmask_b32 v5, 0, v146, vcc
    v_cmp_eq_u32 vcc, 2, v147
    s_nop 1
    v_cndmask_b32 v6, 0, v146, vcc
    v_cmp_eq_u32 vcc, 3, v147
    s_nop 1
    v_cndmask_b32 v7, 0, v146, vcc
    s_setprio 3
    s_mul_i32 s83, s86, 528
    v_lshlrev_b32 v139, 4, v1
    v_add_u32 v138, s83, v139
    v_min_u32 v139, 512, v139
    s_lshl_b32 s83, s80, 3
    s_add_u32 s83, s83, s81
    s_mul_i32 s83, s83, 768
    s_add_u32 s83, s83, 262144
    v_lshl_add_u32 v145, v1, 3, s83
    s_mov_b32 exec_hi, 0
    v_and_b32 v146, 15, v1
    v_lshl_add_u32 v145, v146, 4, s83
    v_lshrrev_b32 v146, 4, v1
    v_lshl_add_u32 v145, v146, 3, v145
    s_mov_b32 exec_hi, -1
    v_mov_b32 v147, 0
L_lp:
    ds_read_b64 v[136:137], v2 offset:320
    s_waitcnt lgkmcnt(0)
    v_max_u32 v146, v136, v137
    v_cmp_eq_u32 vcc, -1, v146
    s_cbranch_vccz L_lp_ok
    s_sub_i32 s90, s90, 1
    s_cmp_lt_i32 s90, 0
    s_cbranch_scc0 L_lp
L_lp_ok:
    v_and_b32_dpp v152, v136, v4 row_newbcast:0 row_mask:0xf bank_mask:0xf
    v_and_b32_dpp v153, v136, v5 row_newbcast:0 row_mask:0xf bank_mask:0xf
    v_and_b32_dpp v154, v136, v6 row_newbcast:0 row_mask:0xf bank_mask:0xf
    v_and_b32_dpp v155, v136, v7 row_newbcast:0 row_mask:0xf bank_mask:0xf
    v_and_b32_dpp v156, v136, v4 row_newbcast:1 row_mask:0xf bank_mask:0xf
    v_and_b32_dpp v157, v136, v5 row_newbcast:1 row_mask:0xf bank_mask:0xf
    v_and_b32_dpp v158, v136, v6 row_newbcast:1 row_mask:0xf bank_mask:0xf
    v_and_b32_dpp v159, v136, v7 row_newbcast:1 row_mask:0xf bank_mask:0xf
    v_and_b32_dpp v160, v136, v4 row_newbcast:2 row_mask:0xf bank_mask:0xf
    v_and_b32_dpp v161, v136, v5 row_newbcast:2 row_mask:0xf bank_mask:0xf
    v_and_b32_dpp v162, v136, v6 row_newbcast:2 row_mask:0xf bank_mask:0xf
    v_and_b32_dpp v163, v136, v7 row_newbcast:2 row_mask:0xf bank_mask:0xf
    s_waitcnt vmcnt(31)
    v_mfma_f32_16x16x32_bf16 v[164:167], v[152:155], v[8:11], 0
    v_and_b32_dpp v152, v136, v4 row_newbcast:3 row_mask:0xf bank_mask:0xf
    v_and_b32_dpp v153, v136, v5 row_newbcast:3 row_mask:0xf bank_mask:0xf
    v_and_b32_dpp v154, v136, v6 row_newbcast:3 row_mask:0xf bank_mask:0xf
    v_and_b32_dpp v155, v136, v7 row_newbcast:3 row_mask:0xf bank_mask:0xf
    s_waitcnt vmcnt(30)
    v_mfma_f32_16x16x32_bf16 v[164:167], v[156:159], v[12:15], v[164:167]
    v_and_b32_dpp v156, v136, v4 row_newbcast:4 row_mask:0xf bank_mask:0xf
    v_and_b32_dpp v157, v136, v5 row_newbcast:4 row_mask:0xf bank_mask:0xf
    v_and_b32_dpp v158, v136, v6 row_newbcast:4 row_mask:0xf bank_mask:0xf
    v_and_b32_dpp v159, v136, v7 row_newbcast:4 row_mask:0xf bank_mask:0xf
    s_waitcnt vmcnt(29)
    v_mfma_f32_16x16x32_bf16 v[164:167], v[160:163], v[16:19], v[164:167]
    v_and_b32_dpp v160, v136, v4 row_newbcast:5 row_mask:0xf bank_mask:0xf
    v_and_b32_dpp v161, v136, v5 row_newbcast:5 row_mask:0xf bank_mask:0xf
    v_and_b32_dpp v162, v136, v6 row_newbcast:5 row_mask:0xf bank_mask:0xf
    v_and_b32_dpp v163, v136, v7 row_newbcast:5 row_mask:0xf bank_mask:0xf
    s_waitcnt vmcnt(28)
    v_mfma_f32_16x16x32_bf16 v[164:167], v[152:155], v[20:23], v[164:167]
    v_and_b32_dpp v152, v136, v4 row_newbcast:6 row_mask:0xf bank_mask:0xf
    v_and_b32_dpp v153, v136, v5 row_newbcast:6 row_mask:0xf bank_mask:0xf
    v_and_b32_dpp v154, v136, v6 row_newbcast:6 row_mask:0xf bank_mask:0xf
    v_and_b32_dpp v155, v136, v7 row_newbcast:6 row_mask:0xf bank_mask:0xf
    s_waitcnt vmcnt(27)
    v_mfma_f32_16x16x32_bf16 v[164:167], v[156:159], v[24:27], v[164:167]
    v_and_b32_dpp v156, v136, v4 row_newbcast:7 row_mask:0xf bank_mask:0xf
    v_and_b32_dpp v157, v136, v5 row_newbcast:7 row_mask:0xf bank_mask:0xf
    v_and_b32_dpp v158, v136, v6 row_newbcast:7 row_mask:0xf bank_mask:0xf
    v_and_b32_dpp v159, v136, v7 row_newbcast:7 row_mask:0xf bank_mask:0xf
    s_waitcnt vmcnt(26)
    v_mfma_f32_16x16x32_bf16 v[164:167], v[160:163], v[28:31], v[164:167]
    v_and_b32_dpp v160, v136, v4 row_newbcast:8 row_mask:0xf bank_mask:0xf
    v_and_b32_dpp v161, v136, v5 row_newbcast:8 row_mask:0xf bank_mask:0xf
    v_and_b32_dpp v162, v136, v6 row_newbcast:8 row_mask:0xf bank_mask:0xf
    v_and_b32_dpp v163, v136, v7 row_newbcast:8 row_mask:0xf bank_mask:0xf
    s_waitcnt vmcnt(25)
    v_mfma_f32_16x16x32_bf16 v[164:167], v[152:155], v[32:35], v[164:167]
    v_and_b32_dpp v152, v136, v4 row_newbcast:9 row_mask:0xf bank_mask:0xf
    v_and_b32_dpp v153, v136, v5 row_newbcast:9 row_mask:0xf bank_mask:0xf
    v_and_b32_dpp v154, v136, v6 row_newbcast:9 row_mask:0xf bank_mask:0xf
    v_and_b32_dpp v155, v136, v7 row_newbcast:9 row_mask:0xf bank_mask:0xf
    s_waitcnt vmcnt(24)
    v_mfma_f32_16x16x32_bf16 v[164:167], v[156:159], v[36:39], v[164:167]
    v_and_b32_dpp v156, v136, v4 row_newbcast:10 row_mask:0xf bank_mask:0xf
    v_and_b32_dpp v157, v136, v5 row_newbcast:10 row_mask:0xf bank_mask:0xf
    v_and_b32_dpp v158, v136, v6 row_newbcast:10 row_mask:0xf bank_mask:0xf
    v_and_b32_dpp v159, v136, v7 row_newbcast:10 row_mask:0xf bank_mask:0xf
    s_waitcnt vmcnt(23)
    v_mfma_f32_16x16x32_bf16 v[164:167], v[160:163], v[40:43], v[164:167]
    v_and_b32_dpp v160, v136, v4 row_newbcast:11 row_mask:0xf bank_mask:0xf
    v_and_b32_dpp v161, v136, v5 row_newbcast:11 row_mask:0xf bank_mask:0xf
    v_and_b32_dpp v162, v136, v6 row_newbcast:11 row_mask:0xf bank_mask:0xf
    v_and_b32_dpp v163, v136, v7 row_newbcast:11 row_mask:0xf bank_mask:0xf
    s_waitcnt vmcnt(22)
    v_mfma_f32_16x16x32_bf16 v[164:167], v[152:155], v[44:47], v[164:167]
    v_and_b32_dpp v152, v136, v4 row_newbcast:12 row_mask:0xf bank_mask:0xf
    v_and_b32_dpp v153, v136, v5 row_newbcast:12 row_mask:0xf bank_mask:0xf
    v_and_b32_dpp v154, v136, v6 row_newbcast:12 row_mask:0xf bank_mask:0xf
    v_and_b32_dpp v155, v136, v7 row_newbcast:12 row_mask:0xf bank_mask:0xf
    s_waitcnt vmcnt(21)
    v_mfma_f32_16x16x32_bf16 v[164:167], v[156:159], v[48:51], v[164:167]
    v_and_b32_dpp v156, v136, v4 row_newbcast:13 row_mask:0xf bank_mask:0xf
    v_and_b32_dpp v157, v136, v5 row_newbcast:13 row_mask:0xf bank_mask:0xf
    v_and_b32_dpp v158, v136, v6 row_newbcast:13 row_mask:0xf bank_mask:0xf
    v_and_b32_dpp v159, v136, v7 row_newbcast:13 row_mask:0xf bank_mask:0xf
    s_waitcnt vmcnt(20)
    v_mfma_f32_16x16x32_bf16 v[164:167], v[160:163], v[52:55], v[164:167]
    v_and_b32_dpp v160, v136, v4 row_newbcast:14 row_mask:0xf bank_mask:0xf
    v_and_b32_dpp v161, v136, v5 row_newbcast:14 row_mask:0xf bank_mask:0xf
    v_and_b32_dpp v162, v136, v6 row_newbcast:14 row_mask:0xf bank_mask:0xf
    v_and_b32_dpp v163, v136, v7 row_newbcast:14 row_mask:0xf bank_mask:0xf
    s_waitcnt vmcnt(19)
    v_mfma_f32_16x16x32_bf16 v[164:167], v[152:155], v[56:59], v[164:167]
    v_and_b32_dpp v152, v136, v4 row_newbcast:15 row_mask:0xf bank_mask:0xf
    v_and_b32_dpp v153, v136, v5 row_newbcast:15 row_mask:0xf bank_mask:0xf
    v_and_b32_dpp v154, v136, v6 row_newbcast:15 row_mask:0xf bank_mask:0xf
    v_and_b32_dpp v155, v136, v7 row_newbcast:15 row_mask:0xf bank_mask:0xf
    s_waitcnt vmcnt(18)
    v_mfma_f32_16x16x32_bf16 v[164:167], v[156:159], v[60:63], v[164:167]
    v_and_b32_dpp v156, v137, v4 row_newbcast:0 row_mask:0xf bank_mask:0xf
    v_and_b32_dpp v157, v137, v5 row_newbcast:0 row_mask:0xf bank_mask:0xf
    v_and_b32_dpp v158, v137, v6 row_newbcast:0 row_mask:0xf bank_mask:0xf
    v_and_b32_dpp v159, v137, v7 row_newbcast:0 row_mask:0xf bank_mask:0xf
    s_waitcnt vmcnt(17)
    v_mfma_f32_16x16x32_bf16 v[164:167], v[160:163], v[64:67], v[164:167]
    v_and_b32_dpp v160, v137, v4 row_newbcast:1 row_mask:0xf bank_mask:0xf
    v_and_b32_dpp v161, v137, v5 row_newbcast:1 row_mask:0xf bank_mask:0xf
    v_and_b32_dpp v162, v137, v6 row_newbcast:1 row_mask:0xf bank_mask:0xf
    v_and_b32_dpp v163, v137, v7 row_newbcast:1 row_mask:0xf bank_mask:0xf
    s_waitcnt vmcnt(16)
    v_mfma_f32_16x16x32_bf16 v[164:167], v[152:155], v[68:71], v[164:167]
    v_and_b32_dpp v152, v137, v4 row_newbcast:2 row_mask:0xf bank_mask:0xf
    v_and_b32_dpp v153, v137, v5 row_newbcast:2 row_mask:0xf bank_mask:0xf
    v_and_b32_dpp v154, v137, v6 row_newbcast:2 row_mask:0xf bank_mask:0xf
    v_and_b32_dpp v155, v137, v7 row_newbcast:2 row_mask:0xf bank_mask:0xf
    s_waitcnt vmcnt(15)
    v_mfma_f32_16x16x32_bf16 v[164:167], v[156:159], v[72:75], v[164:167]
    v_and_b32_dpp v156, v137, v4 row_newbcast:3 row_mask:0xf bank_mask:0xf
    v_and_b32_dpp v157, v137, v5 row_newbcast:3 row_mask:0xf bank_mask:0xf
    v_and_b32_dpp v158, v137, v6 row_newbcast:3 row_mask:0xf bank_mask:0xf
    v_and_b32_dpp v159, v137, v7 row_newbcast:3 row_mask:0xf bank_mask:0xf
    s_waitcnt vmcnt(14)
    v_mfma_f32_16x16x32_bf16 v[164:167], v[160:163], v[76:79], v[164:167]
    v_and_b32_dpp v160, v137, v4 row_newbcast:4 row_mask:0xf bank_mask:0xf
    v_and_b32_dpp v161, v137, v5 row_newbcast:4 row_mask:0xf bank_mask:0xf
    v_and_b32_dpp v162, v137, v6 row_newbcast:4 row_mask:0xf bank_mask:0xf
    v_and_b32_dpp v163, v137, v7 row_newbcast:4 row_mask:0xf bank_mask:0xf
    s_waitcnt vmcnt(13)
    v_mfma_f32_16x16x32_bf16 v[164:167], v[152:155], v[80:83], v[164:167]
    v_and_b32_dpp v152, v137, v4 row_newbcast:5 row_mask:0xf bank_mask:0xf
    v_and_b32_dpp v153, v137, v5 row_newbcast:5 row_mask:0xf bank_mask:0xf
    v_and_b32_dpp v154, v137, v6 row_newbcast:5 row_mask:0xf bank_mask:0xf
    v_and_b32_dpp v155, v137, v7 row_newbcast:5 row_mask:0xf bank_mask:0xf
    s_waitcnt vmcnt(12)
    v_mfma_f32_16x16x32_bf16 v[164:167], v[156:159], v[84:87], v[164:167]
    v_and_b32_dpp v156, v137, v4 row_newbcast:6 row_mask:0xf bank_mask:0xf
    v_and_b32_dpp v157, v137, v5 row_newbcast:6 row_mask:0xf bank_mask:0xf
    v_and_b32_dpp v158, v137, v6 row_newbcast:6 row_mask:0xf bank_mask:0xf
    v_and_b32_dpp v159, v137, v7 row_newbcast:6 row_mask:0xf bank_mask:0xf
    s_waitcnt vmcnt(11)
    v_mfma_f32_16x16x32_bf16 v[164:167], v[160:163], v[88:91], v[164:167]
    v_and_b32_dpp v160, v137, v4 row_newbcast:7 row_mask:0xf bank_mask:0xf
    v_and_b32_dpp v161, v137, v5 row_newbcast:7 row_mask:0xf bank_mask:0xf
    v_and_b32_dpp v162, v137, v6 row_newbcast:7 row_mask:0xf bank_mask:0xf
    v_and_b32_dpp v163, v137, v7 row_newbcast:7 row_mask:0xf bank_mask:0xf
    s_waitcnt vmcnt(10)
    v_mfma_f32_16x16x32_bf16 v[164:167], v[152:155], v[92:95], v[164:167]
    v_and_b32_dpp v152, v137, v4 row_newbcast:8 row_mask:0xf bank_mask:0xf
    v_and_b32_dpp v153, v137, v5 row_newbcast:8 row_mask:0xf bank_mask:0xf
    v_and_b32_dpp v154, v137, v6 row_newbcast:8 row_mask:0xf bank_mask:0xf
    v_and_b32_dpp v155, v137, v7 row_newbcast:8 row_mask:0xf bank_mask:0xf
    s_waitcnt vmcnt(9)
    v_mfma_f32_16x16x32_bf16 v[164:167], v[156:159], v[96:99], v[164:167]
    v_and_b32_dpp v156, v137, v4 row_newbcast:9 row_mask:0xf bank_mask:0xf
    v_and_b32_dpp v157, v137, v5 row_newbcast:9 row_mask:0xf bank_mask:0xf
    v_and_b32_dpp v158, v137, v6 row_newbcast:9 row_mask:0xf bank_mask:0xf
    v_and_b32_dpp v159, v137, v7 row_newbcast:9 row_mask:0xf bank_mask:0xf
    s_waitcnt vmcnt(8)
    v_mfma_f32_16x16x32_bf16 v[164:167], v[160:163], v[100:103], v[164:167]
    v_and_b32_dpp v160, v137, v4 row_newbcast:10 row_mask:0xf bank_mask:0xf
    v_and_b32_dpp v161, v137, v5 row_newbcast:10 row_mask:0xf bank_mask:0xf
    v_and_b32_dpp v162, v137, v6 row_newbcast:10 row_mask:0xf bank_mask:0xf
    v_and_b32_dpp v163, v137, v7 row_newbcast:10 row_mask:0xf bank_mask:0xf
    s_waitcnt vmcnt(7)
    v_mfma_f32_16x16x32_bf16 v[164:167], v[152:155], v[104:107], v[164:167]
    v_and_b32_dpp v152, v137, v4 row_newbcast:11 row_mask:0xf bank_mask:0xf
    v_and_b32_dpp v153, v137, v5 row_newbcast:11 row_mask:0xf bank_mask:0xf
    v_and_b32_dpp v154, v137, v6 row_newbcast:11 row_mask:0xf bank_mask:0xf
    v_and_b32_dpp v155, v137, v7 row_newbcast:11 row_mask:0xf bank_mask:0xf
    s_waitcnt vmcnt(6)
    v_mfma_f32_16x16x32_bf16 v[164:167], v[156:159], v[108:111], v[164:167]
    v_and_b32_dpp v156, v137, v4 row_newbcast:12 row_mask:0xf bank_mask:0xf
    v_and_b32_dpp v157, v137, v5 row_newbcast:12 row_mask:0xf bank_mask:0xf
    v_and_b32_dpp v158, v137, v6 row_newbcast:12 row_mask:0xf bank_mask:0xf
    v_and_b32_dpp v159, v137, v7 row_newbcast:12 row_mask:0xf bank_mask:0xf
    s_waitcnt vmcnt(5)
    v_mfma_f32_16x16x32_bf16 v[164:167], v[160:163], v[112:115], v[164:167]
    v_and_b32_dpp v160, v137, v4 row_newbcast:13 row_mask:0xf bank_mask:0xf
    v_and_b32_dpp v161, v137, v5 row_newbcast:13 row_mask:0xf bank_mask:0xf
    v_and_b32_dpp v162, v137, v6 row_newbcast:13 row_mask:0xf bank_mask:0xf
    v_and_b32_dpp v163, v137, v7 row_newbcast:13 row_mask:0xf bank_mask:0xf
    s_waitcnt vmcnt(4)
    v_mfma_f32_16x16x32_bf16 v[164:167], v[152:155], v[116:119], v[164:167]
    v_and_b32_dpp v152, v137, v4 row_newbcast:14 row_mask:0xf bank_mask:0xf
    v_and_b32_dpp v153, v137, v5 row_newbcast:14 row_mask:0xf bank_mask:0xf
    v_and_b32_dpp v154, v137, v6 row_newbcast:14 row_mask:0xf bank_mask:0xf
    v_and_b32_dpp v155, v137, v7 row_newbcast:14 row_mask:0xf bank_mask:0xf
    s_waitcnt vmcnt(3)
    v_mfma_f32_16x16x32_bf16 v[164:167], v[156:159], v[120:123], v[164:167]
    v_and_b32_dpp v156, v137, v4 row_newbcast:15 row_mask:0xf bank_mask:0xf
    v_and_b32_dpp v157, v137, v5 row_newbcast:15 row_mask:0xf bank_mask:0xf
    v_and_b32_dpp v158, v137, v6 row_newbcast:15 row_mask:0xf bank_mask:0xf
    v_and_b32_dpp v159, v137, v7 row_newbcast:15 row_mask:0xf bank_mask:0xf
    s_waitcnt vmcnt(2)
    v_mfma_f32_16x16x32_bf16 v[164:167], v[160:163], v[124:127], v[164:167]
    s_waitcnt vmcnt(1)
    v_mfma_f32_16x16x32_bf16 v[164:167], v[152:155], v[128:131], v[164:167]
    s_waitcnt vmcnt(0)
    v_mfma_f32_16x16x32_bf16 v[164:167], v[156:159], v[132:135], v[164:167]
    s_mov_b32 exec_hi, 0
    s_nop 6
    ds_write_b128 v138, v[164:167] offset:2368
    s_mov_b32 exec_hi, 0xffff
    ds_read_b128 v[8:11], v139 offset:2368
    ds_read_b128 v[12:15], v139 offset:2896
    ds_read_b128 v[16:19], v139 offset:3424
    ds_read_b128 v[20:23], v139 offset:3952
    s_waitcnt lgkmcnt(2)
    v_pk_add_f32 v[8:9], v[8:9], v[12:13]
    v_pk_add_f32 v[10:11], v[10:11], v[14:15]
    s_waitcnt lgkmcnt(0)
    v_pk_add_f32 v[16:17], v[16:17], v[20:21]
    v_pk_add_f32 v[18:19], v[18:19], v[22:23]
    v_pk_add_f32 v[8:9], v[8:9], v[16:17]
    v_pk_add_f32 v[10:11], v[10:11], v[18:19]
    v_cmp_u_f32 vcc, v8, v11
    s_mov_b32 exec_hi, 0
    v_cvt_pk_bf16_f32 v8, v8, v9
    v_cvt_pk_bf16_f32 v9, v10, v11
    s_cmp_eq_u64 vcc, 0
    s_cselect_b32 exec_lo, -1, 0
    s_cselect_b32 exec_hi, 0xffff, 0
    buffer_store_dwordx2 v[8:9], v145, s[32:35], 0 offen
    buffer_store_dwordx2 v[8:9], v145, s[32:35], 0 offen offset:384 sc1
    ds_write_b32 v147, v147 offset:32
    s_mov_b64 exec, -1
    s_cmp_lt_u32 s2, 120
    s_cbranch_scc0 L_fin
    s_setprio 0
L_r2:
    ds_read_b32 v146, v147 offset:40
    s_waitcnt lgkmcnt(0)
    v_cmp_eq_u32 vcc, -1, v146
    s_cbranch_vccz L_r2_ok
    s_sub_i32 s90, s90, 1
    s_cmp_lt_i32 s90, 0
    s_cbranch_scc0 L_r2
L_r2_ok:
    v_readfirstlane_b32 s87, v146
    s_cmp_ge_u32 s87, 43
    s_cbranch_scc1 L_fin
L_r3:
    ds_read_b32 v146, v147 offset:32
    s_waitcnt lgkmcnt(0)
    v_cmp_eq_u32 vcc, -1, v146
    s_cbranch_vccz L_r3_ok
    s_sub_i32 s90, s90, 1
    s_cmp_lt_i32 s90, 0
    s_cbranch_scc0 L_r3
L_r3_ok:
    s_lshl_b32 s83, s87, 6
    v_and_b32 v146, 7, v1
    v_and_b32 v147, 48, v1
    v_lshl_add_u32 v146, v146, 1, s83
    v_add_u32 v146, v146, v147
    global_load_ushort v144, v146, s[70:71]
    s_branch L_mlp0
L_fin:
L_end:
    s_endpgm
.section .rodata,"a"
.p2align 6
.amdhsa_kernel sequential_preLN__gqa_block_cached__mixer_channel_mlp__decode_kernel
  .amdhsa_next_free_vgpr 168
  .amdhsa_next_free_sgpr 102
  .amdhsa_accum_offset 168
  .amdhsa_group_segment_fixed_size 0
  .amdhsa_kernarg_size 104
  .amdhsa_user_sgpr_count 2
  .amdhsa_user_sgpr_kernarg_segment_ptr 1
  .amdhsa_system_sgpr_workgroup_id_x 1
.end_amdhsa_kernel
```
